```python
import torch

def _softmax(x, axis=-1):
    return torch.softmax(x, dim=axis)
def _gelu(x):
    return torch.nn.functional.gelu(x, approximate="tanh")
def _silu(x):
    return torch.nn.functional.silu(x)
def _sigmoid(x):
    return torch.sigmoid(x)
def _layernorm(x, axis=-1, eps=1e-5):
    m = x.mean(dim=axis, keepdim=True)
    v = x.var(dim=axis, keepdim=True, unbiased=False)
    return (x - m) / torch.sqrt(v + eps)
def _scatter_add(tgt, idx, src, axis=0):
    return tgt.clone().index_add_(axis, idx, src)
def _segment_sum(src, seg, n):
    out = torch.zeros((n,) + src.shape[1:], dtype=src.dtype)
    return out.index_add_(0, seg, src)
def _pad(x, pw):
    flat = tuple(v for pair in reversed(pw) for v in pair)
    return torch.nn.functional.pad(x, flat)

kernel_name = 'parallel_sum__gqa_block_cached__swiglu_ffn__decode'

def setup_inputs():

    _w = (lambda a: (lambda t: t.to(torch.bfloat16) if t.is_floating_point() else t)(torch.as_tensor(a)))
    def _A_setup():
        B, Sq, D = 1, 1, 576
        Hq, Hkv, Sk, Dh = 32, 16, 8192, 128
        assert Hq % Hkv == 0, (Hq, Hkv)
        return {
            "x": _w((lambda *s: torch.randn(*s, dtype=torch.bfloat16) * 0.05)(B, Sq, D)),
            "k_cache": _w((lambda *s: torch.randn(*s, dtype=torch.bfloat16) * 3.2)(B, Hkv, Sk, Dh)),
            "v_cache": _w((lambda *s: torch.randn(*s, dtype=torch.bfloat16) * 1.6)(B, Hkv, Sk, Dh)),
            "wq": _w((lambda *s: torch.randn(*s, dtype=torch.bfloat16) * 3.2)(D, Hq * Dh) * (D ** -0.5)),
            "wo": _w((lambda *s: torch.randn(*s, dtype=torch.bfloat16) * 1.6)(Hq * Dh, D) * ((Hq * Dh) ** -0.5)),
        }
    _A_in = _A_setup()

    def _B_setup():
        B, S, D, F = 1, 1, 576, 4608
        return {
            "x": _w((lambda *s: torch.randn(*s, dtype=torch.bfloat16) * 0.05)(B, S, D)),
            "w_gate": _w((lambda *s: torch.randn(*s, dtype=torch.bfloat16) * 0.05)(D, F)),
            "w_up": _w((lambda *s: torch.randn(*s, dtype=torch.bfloat16) * 0.05)(D, F)),
            "w_down": _w((lambda *s: torch.randn(*s, dtype=torch.bfloat16) * 0.05)(F, D)),
        }
    _B_in = _B_setup()

    return {
        "A_x": _A_in["x"],
        "A_k_cache": _A_in["k_cache"],
        "A_v_cache": _A_in["v_cache"],
        "A_wq": _A_in["wq"],
        "A_wo": _A_in["wo"],
        "B_x": _B_in["x"],
        "B_w_gate": _B_in["w_gate"],
        "B_w_up": _B_in["w_up"],
        "B_w_down": _B_in["w_down"],
    }

def reference(A_x, A_k_cache, A_v_cache, A_wq, A_wo, B_x, B_w_gate, B_w_up, B_w_down):
    def _A_ref(x, k_cache, v_cache, wq, wo):
        B, Sq, D = x.shape
        Hq, Dh = 32, 128
        Hkv = k_cache.shape[1]
        rep = Hq // Hkv
        q = (lambda x, *d: x.permute(*d))((x @ wq).reshape(B, Sq, Hq, Dh), 0, 2, 1, 3)
        k = (lambda x, n, axis: torch.repeat_interleave(x, n, dim=axis))(k_cache, rep, axis=1)
        v = (lambda x, n, axis: torch.repeat_interleave(x, n, dim=axis))(v_cache, rep, axis=1)
        scores = torch.einsum("bhqd,bhkd->bhqk", q, k) * (Dh ** -0.5)
        p = _softmax(scores, axis=-1)
        o = torch.einsum("bhqk,bhkd->bhqd", p, v)
        return (lambda x, *d: x.permute(*d))(o, 0, 2, 1, 3).reshape(B, Sq, Hq * Dh) @ wo

    def _B_ref(x, w_gate, w_up, w_down):
        g = _silu(x @ w_gate)
        u = x @ w_up
        return (g * u) @ w_down

    x = A_x
    xn = _layernorm(x, axis=-1)
    return x + _A_ref(xn, A_k_cache, A_v_cache, A_wq, A_wo) + _B_ref(xn, B_w_gate, B_w_up, B_w_down)
```

```asm
; @launch grid=(256,1,1) block=(512,1,1) lds=147456
.amdgcn_target "amdgcn-amd-amdhsa--gfx950"
.text
.globl parallel_sum__gqa_block_cached__swiglu_ffn__decode_kernel
.p2align 8
.type parallel_sum__gqa_block_cached__swiglu_ffn__decode_kernel,@function
parallel_sum__gqa_block_cached__swiglu_ffn__decode_kernel:
    s_cmp_ge_u32 s2, 256
    s_cbranch_scc1 L_end
    s_load_dwordx16 s[8:23], s[0:1], 0
    s_load_dwordx8 s[24:31], s[0:1], 64
    v_and_b32 v1, 63, v0
    v_lshrrev_b32 v2, 6, v0
    v_and_b32 v3, 15, v1
    v_lshrrev_b32 v4, 4, v1
    v_mov_b32 v7, 0
    v_readfirstlane_b32 s34, v2
    s_and_b32 s32, s2, 7
    s_lshl_b32 s32, s32, 1
    s_bfe_u32 s3, s2, 0x10003
    s_or_b32 s32, s32, s3
    s_lshr_b32 s33, s2, 4
    s_lshr_b32 s35, s33, 3
    s_and_b32 s36, s33, 7
    s_mov_b32 s37, 0x05040100
    s_mov_b32 s38, 0x07060302
    s_mov_b32 s39, 0xffff0000
    s_mov_b32 s44, 0x3fb8aa3b
    v_mov_b32 v8, 0
    v_mov_b32 v9, 0
    v_mov_b32 v10, 0
    v_mov_b32 v11, 0
    v_lshlrev_b32 v12, 4, v0
    ds_write_b128 v12, v[8:11]
    s_waitcnt lgkmcnt(0)
    s_barrier
    s_cmp_ge_u32 s34, 4
    s_cbranch_scc1 L_aux
    v_lshlrev_b32 v5, 8, v3
    v_lshl_add_u32 v5, v4, 4, v5
    v_lshlrev_b32 v6, 10, v4
    v_lshl_add_u32 v6, v3, 4, v6
    s_lshl_b32 s56, s32, 21
    s_lshl_b32 s57, s33, 17
    s_add_u32 s56, s56, s57
    s_lshl_b32 s57, s34, 15
    s_add_u32 s56, s56, s57
    s_add_u32 s58, s57, 16384
    s_add_u32 s40, s10, s56
    s_addc_u32 s41, s11, 0
    s_add_u32 s42, s12, s56
    s_addc_u32 s43, s13, 0
    s_mov_b32 s60, 0
    s_add_u32 m0, s58, 0
    s_nop 0
    global_load_lds_dwordx4 v5, s[40:41] offset:0 nt
    s_add_u32 m0, s58, 960
    s_nop 0
    global_load_lds_dwordx4 v5, s[40:41] offset:64 nt
    s_add_u32 m0, s58, 1920
    s_nop 0
    global_load_lds_dwordx4 v5, s[40:41] offset:128 nt
    s_add_u32 m0, s58, 2880
    s_nop 0
    global_load_lds_dwordx4 v5, s[40:41] offset:192 nt
    s_add_u32 s40, s40, 4096
    s_addc_u32 s41, s41, 0
    s_mov_b32 s45, 3200000
L_lw_1:
    ds_read_b32 v8, v7 offset:20
    s_waitcnt lgkmcnt(0)
    v_readfirstlane_b32 s52, v8
    s_cmp_eq_u32 s52, 3
    s_cbranch_scc1 L_lwd_2
    s_sleep 1
    s_sub_u32 s45, s45, 1
    s_cmp_lg_u32 s45, 0
    s_cbranch_scc1 L_lw_1
L_lwd_2:
    s_add_u32 m0, s58, 4096
    s_nop 0
    global_load_lds_dwordx4 v5, s[40:41] offset:0 nt
    s_add_u32 m0, s58, 5056
    s_nop 0
    global_load_lds_dwordx4 v5, s[40:41] offset:64 nt
    s_add_u32 m0, s58, 6016
    s_nop 0
    global_load_lds_dwordx4 v5, s[40:41] offset:128 nt
    s_add_u32 m0, s58, 6976
    s_nop 0
    global_load_lds_dwordx4 v5, s[40:41] offset:192 nt
    s_add_u32 s40, s40, 4096
    s_addc_u32 s41, s41, 0
    s_add_u32 m0, s58, 8192
    s_nop 0
    global_load_lds_dwordx4 v5, s[40:41] offset:0 nt
    s_add_u32 m0, s58, 9152
    s_nop 0
    global_load_lds_dwordx4 v5, s[40:41] offset:64 nt
    s_add_u32 m0, s58, 10112
    s_nop 0
    global_load_lds_dwordx4 v5, s[40:41] offset:128 nt
    s_add_u32 m0, s58, 11072
    s_nop 0
    global_load_lds_dwordx4 v5, s[40:41] offset:192 nt
    s_add_u32 s40, s40, 4096
    s_addc_u32 s41, s41, 0
    s_add_u32 m0, s58, 12288
    s_waitcnt vmcnt(11)
    global_load_lds_dwordx4 v5, s[40:41] offset:0 nt
    s_add_u32 m0, s58, 13248
    s_waitcnt vmcnt(11)
    global_load_lds_dwordx4 v5, s[40:41] offset:64 nt
    s_add_u32 m0, s58, 14208
    s_waitcnt vmcnt(11)
    global_load_lds_dwordx4 v5, s[40:41] offset:128 nt
    s_add_u32 m0, s58, 15168
    s_waitcnt vmcnt(11)
    global_load_lds_dwordx4 v5, s[40:41] offset:192 nt
    s_add_u32 s40, s40, 4096
    s_addc_u32 s41, s41, 0
    s_add_u32 m0, s58, 16384
    s_waitcnt vmcnt(11)
    global_load_lds_dwordx4 v5, s[40:41] offset:0 nt
    s_add_u32 m0, s58, 17344
    s_waitcnt vmcnt(11)
    global_load_lds_dwordx4 v5, s[40:41] offset:64 nt
    s_add_u32 m0, s58, 18304
    s_waitcnt vmcnt(11)
    global_load_lds_dwordx4 v5, s[40:41] offset:128 nt
    s_add_u32 m0, s58, 19264
    s_waitcnt vmcnt(11)
    global_load_lds_dwordx4 v5, s[40:41] offset:192 nt
    s_add_u32 s40, s40, 4096
    s_addc_u32 s41, s41, 0
    s_add_u32 m0, s58, 20480
    s_waitcnt vmcnt(11)
    global_load_lds_dwordx4 v5, s[40:41] offset:0 nt
    s_add_u32 m0, s58, 21440
    s_waitcnt vmcnt(11)
    global_load_lds_dwordx4 v5, s[40:41] offset:64 nt
    s_add_u32 m0, s58, 22400
    s_waitcnt vmcnt(11)
    global_load_lds_dwordx4 v5, s[40:41] offset:128 nt
    s_add_u32 m0, s58, 23360
    s_waitcnt vmcnt(11)
    global_load_lds_dwordx4 v5, s[40:41] offset:192 nt
    s_add_u32 s40, s40, 4096
    s_addc_u32 s41, s41, 0
    s_add_u32 m0, s58, 24576
    s_waitcnt vmcnt(11)
    global_load_lds_dwordx4 v5, s[40:41] offset:0 nt
    s_add_u32 m0, s58, 25536
    s_waitcnt vmcnt(11)
    global_load_lds_dwordx4 v5, s[40:41] offset:64 nt
    s_add_u32 m0, s58, 26496
    s_waitcnt vmcnt(11)
    global_load_lds_dwordx4 v5, s[40:41] offset:128 nt
    s_add_u32 m0, s58, 27456
    s_waitcnt vmcnt(11)
    global_load_lds_dwordx4 v5, s[40:41] offset:192 nt
    s_add_u32 s40, s40, 4096
    s_addc_u32 s41, s41, 0
    s_add_u32 m0, s58, 28672
    s_waitcnt vmcnt(11)
    global_load_lds_dwordx4 v5, s[40:41] offset:0 nt
    s_add_u32 m0, s58, 29632
    s_waitcnt vmcnt(11)
    global_load_lds_dwordx4 v5, s[40:41] offset:64 nt
    s_add_u32 m0, s58, 30592
    s_waitcnt vmcnt(11)
    global_load_lds_dwordx4 v5, s[40:41] offset:128 nt
    s_add_u32 m0, s58, 31552
    s_waitcnt vmcnt(11)
    global_load_lds_dwordx4 v5, s[40:41] offset:192 nt
    s_add_u32 s40, s40, 4096
    s_addc_u32 s41, s41, 0
    s_waitcnt vmcnt(11)
    global_load_dwordx4 v[128:131], v6, s[42:43] offset:0 nt
    s_waitcnt vmcnt(11)
    global_load_dwordx4 v[132:135], v6, s[42:43] offset:256 nt
    s_waitcnt vmcnt(11)
    global_load_dwordx4 v[136:139], v6, s[42:43] offset:512 nt
    s_waitcnt vmcnt(11)
    global_load_dwordx4 v[140:143], v6, s[42:43] offset:768 nt
    s_add_u32 s42, s42, 4096
    s_addc_u32 s43, s43, 0
    s_waitcnt vmcnt(11)
    global_load_dwordx4 v[144:147], v6, s[42:43] offset:0 nt
    s_waitcnt vmcnt(11)
    global_load_dwordx4 v[148:151], v6, s[42:43] offset:256 nt
    s_waitcnt vmcnt(11)
    global_load_dwordx4 v[152:155], v6, s[42:43] offset:512 nt
    s_waitcnt vmcnt(11)
    global_load_dwordx4 v[156:159], v6, s[42:43] offset:768 nt
    s_add_u32 s42, s42, 4096
    s_addc_u32 s43, s43, 0
    s_waitcnt vmcnt(11)
    global_load_dwordx4 v[160:163], v6, s[42:43] offset:0 nt
    s_waitcnt vmcnt(11)
    global_load_dwordx4 v[164:167], v6, s[42:43] offset:256 nt
    s_waitcnt vmcnt(11)
    global_load_dwordx4 v[168:171], v6, s[42:43] offset:512 nt
    s_waitcnt vmcnt(11)
    global_load_dwordx4 v[172:175], v6, s[42:43] offset:768 nt
    s_add_u32 s42, s42, 4096
    s_addc_u32 s43, s43, 0
    s_cmp_lg_u32 s60, 0
    s_cbranch_scc1 L_noqk_3
    ds_read_b32 v8, v7 offset:0
    s_waitcnt lgkmcnt(0)
    v_readfirstlane_b32 s52, v8
    s_cmp_eq_u32 s52, 0
    s_cbranch_scc1 L_noqk_3
    s_call_b64 s[94:95], L_qk
L_noqk_3:
    s_waitcnt vmcnt(11)
    global_load_dwordx4 v[176:179], v6, s[42:43] offset:0 nt
    s_waitcnt vmcnt(11)
    global_load_dwordx4 v[180:183], v6, s[42:43] offset:256 nt
    s_waitcnt vmcnt(11)
    global_load_dwordx4 v[184:187], v6, s[42:43] offset:512 nt
    s_waitcnt vmcnt(11)
    global_load_dwordx4 v[188:191], v6, s[42:43] offset:768 nt
    s_add_u32 s42, s42, 4096
    s_addc_u32 s43, s43, 0
    s_cmp_lg_u32 s60, 0
    s_cbranch_scc1 L_noqk_4
    ds_read_b32 v8, v7 offset:0
    s_waitcnt lgkmcnt(0)
    v_readfirstlane_b32 s52, v8
    s_cmp_eq_u32 s52, 0
    s_cbranch_scc1 L_noqk_4
    s_call_b64 s[94:95], L_qk
L_noqk_4:
    s_waitcnt vmcnt(11)
    global_load_dwordx4 v[192:195], v6, s[42:43] offset:0 nt
    s_waitcnt vmcnt(11)
    global_load_dwordx4 v[196:199], v6, s[42:43] offset:256 nt
    s_waitcnt vmcnt(11)
    global_load_dwordx4 v[200:203], v6, s[42:43] offset:512 nt
    s_waitcnt vmcnt(11)
    global_load_dwordx4 v[204:207], v6, s[42:43] offset:768 nt
    s_add_u32 s42, s42, 4096
    s_addc_u32 s43, s43, 0
    s_cmp_lg_u32 s60, 0
    s_cbranch_scc1 L_noqk_5
    ds_read_b32 v8, v7 offset:0
    s_waitcnt lgkmcnt(0)
    v_readfirstlane_b32 s52, v8
    s_cmp_eq_u32 s52, 0
    s_cbranch_scc1 L_noqk_5
    s_call_b64 s[94:95], L_qk
L_noqk_5:
    s_waitcnt vmcnt(11)
    global_load_dwordx4 v[208:211], v6, s[42:43] offset:0 nt
    s_waitcnt vmcnt(11)
    global_load_dwordx4 v[212:215], v6, s[42:43] offset:256 nt
    s_waitcnt vmcnt(11)
    global_load_dwordx4 v[216:219], v6, s[42:43] offset:512 nt
    s_waitcnt vmcnt(11)
    global_load_dwordx4 v[220:223], v6, s[42:43] offset:768 nt
    s_add_u32 s42, s42, 4096
    s_addc_u32 s43, s43, 0
    s_cmp_lg_u32 s60, 0
    s_cbranch_scc1 L_noqk_6
    ds_read_b32 v8, v7 offset:0
    s_waitcnt lgkmcnt(0)
    v_readfirstlane_b32 s52, v8
    s_cmp_eq_u32 s52, 0
    s_cbranch_scc1 L_noqk_6
    s_call_b64 s[94:95], L_qk
L_noqk_6:
    s_waitcnt vmcnt(11)
    global_load_dwordx4 v[224:227], v6, s[42:43] offset:0 nt
    s_waitcnt vmcnt(11)
    global_load_dwordx4 v[228:231], v6, s[42:43] offset:256 nt
    s_waitcnt vmcnt(11)
    global_load_dwordx4 v[232:235], v6, s[42:43] offset:512 nt
    s_waitcnt vmcnt(11)
    global_load_dwordx4 v[236:239], v6, s[42:43] offset:768 nt
    s_add_u32 s42, s42, 4096
    s_addc_u32 s43, s43, 0
    s_cmp_lg_u32 s60, 0
    s_cbranch_scc1 L_noqk_7
    ds_read_b32 v8, v7 offset:0
    s_waitcnt lgkmcnt(0)
    v_readfirstlane_b32 s52, v8
    s_cmp_eq_u32 s52, 0
    s_cbranch_scc1 L_noqk_7
    s_call_b64 s[94:95], L_qk
L_noqk_7:
    s_waitcnt vmcnt(11)
    global_load_dwordx4 v[240:243], v6, s[42:43] offset:0 nt
    s_waitcnt vmcnt(11)
    global_load_dwordx4 v[244:247], v6, s[42:43] offset:256 nt
    s_waitcnt vmcnt(11)
    global_load_dwordx4 v[248:251], v6, s[42:43] offset:512 nt
    s_waitcnt vmcnt(11)
    global_load_dwordx4 v[252:255], v6, s[42:43] offset:768 nt
    s_add_u32 s42, s42, 4096
    s_addc_u32 s43, s43, 0
    s_mov_b64 exec, 1
    v_mov_b32 v8, 1
    s_waitcnt lgkmcnt(0)
    ds_add_u32 v7, v8 offset:16
    s_mov_b64 exec, -1
    s_cmp_lg_u32 s60, 0
    s_cbranch_scc1 L_qk_done
    s_mov_b32 s45, 3200000
L_lw_8:
    ds_read_b32 v8, v7 offset:0
    s_waitcnt lgkmcnt(0)
    v_readfirstlane_b32 s52, v8
    s_cmp_lg_u32 s52, 0
    s_cbranch_scc1 L_lwd_9
    s_sleep 1
    s_sub_u32 s45, s45, 1
    s_cmp_lg_u32 s45, 0
    s_cbranch_scc1 L_lw_8
L_lwd_9:
    s_call_b64 s[94:95], L_qk
    s_branch L_qk_done
L_qk:
    s_mov_b32 s60, 1
    v_and_b32 v8, 1, v1
    v_lshlrev_b32 v8, 8, v8
    v_lshl_add_u32 v8, v4, 4, v8
    ds_read_b128 v[16:19], v8 offset:256
    ds_read_b128 v[20:23], v8 offset:320
    ds_read_b128 v[24:27], v8 offset:384
    ds_read_b128 v[28:31], v8 offset:448
    v_lshlrev_b32 v9, 4, v1
    v_add_u32 v9, s58, v9
    ds_read_b128 v[64:67], v9 offset:0
    ds_read_b128 v[68:71], v9 offset:1024
    ds_read_b128 v[72:75], v9 offset:2048
    ds_read_b128 v[76:79], v9 offset:3072
    ds_read_b128 v[80:83], v9 offset:4096
    ds_read_b128 v[84:87], v9 offset:5120
    ds_read_b128 v[88:91], v9 offset:6144
    ds_read_b128 v[92:95], v9 offset:7168
    s_waitcnt lgkmcnt(0)
    v_mfma_f32_16x16x32_bf16 v[32:35], v[64:67], v[16:19], 0
    v_mfma_f32_16x16x32_bf16 v[32:35], v[68:71], v[20:23], v[32:35]
    v_mfma_f32_16x16x32_bf16 v[32:35], v[72:75], v[24:27], v[32:35]
    v_mfma_f32_16x16x32_bf16 v[32:35], v[76:79], v[28:31], v[32:35]
    v_mfma_f32_16x16x32_bf16 v[36:39], v[80:83], v[16:19], 0
    v_mfma_f32_16x16x32_bf16 v[36:39], v[84:87], v[20:23], v[36:39]
    v_mfma_f32_16x16x32_bf16 v[36:39], v[88:91], v[24:27], v[36:39]
    v_mfma_f32_16x16x32_bf16 v[36:39], v[92:95], v[28:31], v[36:39]
    ds_read_b128 v[64:67], v9 offset:8192
    ds_read_b128 v[68:71], v9 offset:9216
    ds_read_b128 v[72:75], v9 offset:10240
    ds_read_b128 v[76:79], v9 offset:11264
    ds_read_b128 v[80:83], v9 offset:12288
    ds_read_b128 v[84:87], v9 offset:13312
    ds_read_b128 v[88:91], v9 offset:14336
    ds_read_b128 v[92:95], v9 offset:15360
    s_waitcnt lgkmcnt(0)
    v_mfma_f32_16x16x32_bf16 v[40:43], v[64:67], v[16:19], 0
    v_mfma_f32_16x16x32_bf16 v[40:43], v[68:71], v[20:23], v[40:43]
    v_mfma_f32_16x16x32_bf16 v[40:43], v[72:75], v[24:27], v[40:43]
    v_mfma_f32_16x16x32_bf16 v[40:43], v[76:79], v[28:31], v[40:43]
    v_mfma_f32_16x16x32_bf16 v[44:47], v[80:83], v[16:19], 0
    v_mfma_f32_16x16x32_bf16 v[44:47], v[84:87], v[20:23], v[44:47]
    v_mfma_f32_16x16x32_bf16 v[44:47], v[88:91], v[24:27], v[44:47]
    v_mfma_f32_16x16x32_bf16 v[44:47], v[92:95], v[28:31], v[44:47]
    ds_read_b128 v[64:67], v9 offset:16384
    ds_read_b128 v[68:71], v9 offset:17408
    ds_read_b128 v[72:75], v9 offset:18432
    ds_read_b128 v[76:79], v9 offset:19456
    ds_read_b128 v[80:83], v9 offset:20480
    ds_read_b128 v[84:87], v9 offset:21504
    ds_read_b128 v[88:91], v9 offset:22528
    ds_read_b128 v[92:95], v9 offset:23552
    s_waitcnt lgkmcnt(0)
    v_mfma_f32_16x16x32_bf16 v[48:51], v[64:67], v[16:19], 0
    v_mfma_f32_16x16x32_bf16 v[48:51], v[68:71], v[20:23], v[48:51]
    v_mfma_f32_16x16x32_bf16 v[48:51], v[72:75], v[24:27], v[48:51]
    v_mfma_f32_16x16x32_bf16 v[48:51], v[76:79], v[28:31], v[48:51]
    v_mfma_f32_16x16x32_bf16 v[52:55], v[80:83], v[16:19], 0
    v_mfma_f32_16x16x32_bf16 v[52:55], v[84:87], v[20:23], v[52:55]
    v_mfma_f32_16x16x32_bf16 v[52:55], v[88:91], v[24:27], v[52:55]
    v_mfma_f32_16x16x32_bf16 v[52:55], v[92:95], v[28:31], v[52:55]
    ds_read_b128 v[64:67], v9 offset:24576
    ds_read_b128 v[68:71], v9 offset:25600
    ds_read_b128 v[72:75], v9 offset:26624
    ds_read_b128 v[76:79], v9 offset:27648
    ds_read_b128 v[80:83], v9 offset:28672
    ds_read_b128 v[84:87], v9 offset:29696
    ds_read_b128 v[88:91], v9 offset:30720
    ds_read_b128 v[92:95], v9 offset:31744
    s_waitcnt lgkmcnt(0)
    v_mfma_f32_16x16x32_bf16 v[56:59], v[64:67], v[16:19], 0
    v_mfma_f32_16x16x32_bf16 v[56:59], v[68:71], v[20:23], v[56:59]
    v_mfma_f32_16x16x32_bf16 v[56:59], v[72:75], v[24:27], v[56:59]
    v_mfma_f32_16x16x32_bf16 v[56:59], v[76:79], v[28:31], v[56:59]
    v_mfma_f32_16x16x32_bf16 v[60:63], v[80:83], v[16:19], 0
    v_mfma_f32_16x16x32_bf16 v[60:63], v[84:87], v[20:23], v[60:63]
    v_mfma_f32_16x16x32_bf16 v[60:63], v[88:91], v[24:27], v[60:63]
    v_mfma_f32_16x16x32_bf16 v[60:63], v[92:95], v[28:31], v[60:63]
    s_nop 9
    s_mov_b32 s52, 0x3db504f3
    v_cvt_pk_bf16_f32 v8, v32, v33
    v_lshlrev_b32 v32, 16, v8
    v_and_b32 v33, s39, v8
    v_mul_f32 v32, s52, v32
    v_mul_f32 v33, s52, v33
    v_cvt_pk_bf16_f32 v8, v32, v33
    v_lshlrev_b32 v32, 16, v8
    v_and_b32 v33, s39, v8
    v_cvt_pk_bf16_f32 v8, v34, v35
    v_lshlrev_b32 v34, 16, v8
    v_and_b32 v35, s39, v8
    v_mul_f32 v34, s52, v34
    v_mul_f32 v35, s52, v35
    v_cvt_pk_bf16_f32 v8, v34, v35
    v_lshlrev_b32 v34, 16, v8
    v_and_b32 v35, s39, v8
    v_cvt_pk_bf16_f32 v8, v36, v37
    v_lshlrev_b32 v36, 16, v8
    v_and_b32 v37, s39, v8
    v_mul_f32 v36, s52, v36
    v_mul_f32 v37, s52, v37
    v_cvt_pk_bf16_f32 v8, v36, v37
    v_lshlrev_b32 v36, 16, v8
    v_and_b32 v37, s39, v8
    v_cvt_pk_bf16_f32 v8, v38, v39
    v_lshlrev_b32 v38, 16, v8
    v_and_b32 v39, s39, v8
    v_mul_f32 v38, s52, v38
    v_mul_f32 v39, s52, v39
    v_cvt_pk_bf16_f32 v8, v38, v39
    v_lshlrev_b32 v38, 16, v8
    v_and_b32 v39, s39, v8
    v_cvt_pk_bf16_f32 v8, v40, v41
    v_lshlrev_b32 v40, 16, v8
    v_and_b32 v41, s39, v8
    v_mul_f32 v40, s52, v40
    v_mul_f32 v41, s52, v41
    v_cvt_pk_bf16_f32 v8, v40, v41
    v_lshlrev_b32 v40, 16, v8
    v_and_b32 v41, s39, v8
    v_cvt_pk_bf16_f32 v8, v42, v43
    v_lshlrev_b32 v42, 16, v8
    v_and_b32 v43, s39, v8
    v_mul_f32 v42, s52, v42
    v_mul_f32 v43, s52, v43
    v_cvt_pk_bf16_f32 v8, v42, v43
    v_lshlrev_b32 v42, 16, v8
    v_and_b32 v43, s39, v8
    v_cvt_pk_bf16_f32 v8, v44, v45
    v_lshlrev_b32 v44, 16, v8
    v_and_b32 v45, s39, v8
    v_mul_f32 v44, s52, v44
    v_mul_f32 v45, s52, v45
    v_cvt_pk_bf16_f32 v8, v44, v45
    v_lshlrev_b32 v44, 16, v8
    v_and_b32 v45, s39, v8
    v_cvt_pk_bf16_f32 v8, v46, v47
    v_lshlrev_b32 v46, 16, v8
    v_and_b32 v47, s39, v8
    v_mul_f32 v46, s52, v46
    v_mul_f32 v47, s52, v47
    v_cvt_pk_bf16_f32 v8, v46, v47
    v_lshlrev_b32 v46, 16, v8
    v_and_b32 v47, s39, v8
    v_cvt_pk_bf16_f32 v8, v48, v49
    v_lshlrev_b32 v48, 16, v8
    v_and_b32 v49, s39, v8
    v_mul_f32 v48, s52, v48
    v_mul_f32 v49, s52, v49
    v_cvt_pk_bf16_f32 v8, v48, v49
    v_lshlrev_b32 v48, 16, v8
    v_and_b32 v49, s39, v8
    v_cvt_pk_bf16_f32 v8, v50, v51
    v_lshlrev_b32 v50, 16, v8
    v_and_b32 v51, s39, v8
    v_mul_f32 v50, s52, v50
    v_mul_f32 v51, s52, v51
    v_cvt_pk_bf16_f32 v8, v50, v51
    v_lshlrev_b32 v50, 16, v8
    v_and_b32 v51, s39, v8
    v_cvt_pk_bf16_f32 v8, v52, v53
    v_lshlrev_b32 v52, 16, v8
    v_and_b32 v53, s39, v8
    v_mul_f32 v52, s52, v52
    v_mul_f32 v53, s52, v53
    v_cvt_pk_bf16_f32 v8, v52, v53
    v_lshlrev_b32 v52, 16, v8
    v_and_b32 v53, s39, v8
    v_cvt_pk_bf16_f32 v8, v54, v55
    v_lshlrev_b32 v54, 16, v8
    v_and_b32 v55, s39, v8
    v_mul_f32 v54, s52, v54
    v_mul_f32 v55, s52, v55
    v_cvt_pk_bf16_f32 v8, v54, v55
    v_lshlrev_b32 v54, 16, v8
    v_and_b32 v55, s39, v8
    v_cvt_pk_bf16_f32 v8, v56, v57
    v_lshlrev_b32 v56, 16, v8
    v_and_b32 v57, s39, v8
    v_mul_f32 v56, s52, v56
    v_mul_f32 v57, s52, v57
    v_cvt_pk_bf16_f32 v8, v56, v57
    v_lshlrev_b32 v56, 16, v8
    v_and_b32 v57, s39, v8
    v_cvt_pk_bf16_f32 v8, v58, v59
    v_lshlrev_b32 v58, 16, v8
    v_and_b32 v59, s39, v8
    v_mul_f32 v58, s52, v58
    v_mul_f32 v59, s52, v59
    v_cvt_pk_bf16_f32 v8, v58, v59
    v_lshlrev_b32 v58, 16, v8
    v_and_b32 v59, s39, v8
    v_cvt_pk_bf16_f32 v8, v60, v61
    v_lshlrev_b32 v60, 16, v8
    v_and_b32 v61, s39, v8
    v_mul_f32 v60, s52, v60
    v_mul_f32 v61, s52, v61
    v_cvt_pk_bf16_f32 v8, v60, v61
    v_lshlrev_b32 v60, 16, v8
    v_and_b32 v61, s39, v8
    v_cvt_pk_bf16_f32 v8, v62, v63
    v_lshlrev_b32 v62, 16, v8
    v_and_b32 v63, s39, v8
    v_mul_f32 v62, s52, v62
    v_mul_f32 v63, s52, v63
    v_cvt_pk_bf16_f32 v8, v62, v63
    v_lshlrev_b32 v62, 16, v8
    v_and_b32 v63, s39, v8
    v_max3_f32 v10, v32, v33, v34
    v_max3_f32 v10, v10, v35, v36
    v_max3_f32 v10, v10, v37, v38
    v_max3_f32 v10, v10, v39, v40
    v_max3_f32 v10, v10, v41, v42
    v_max3_f32 v10, v10, v43, v44
    v_max3_f32 v10, v10, v45, v46
    v_max3_f32 v10, v10, v47, v48
    v_max3_f32 v10, v10, v49, v50
    v_max3_f32 v10, v10, v51, v52
    v_max3_f32 v10, v10, v53, v54
    v_max3_f32 v10, v10, v55, v56
    v_max3_f32 v10, v10, v57, v58
    v_max3_f32 v10, v10, v59, v60
    v_max3_f32 v10, v10, v61, v62
    v_max_f32 v10, v10, v63
    v_mov_b32 v8, v10
    s_nop 1
    v_permlane16_swap_b32 v10, v8
    v_max_f32 v10, v10, v8
    v_mov_b32 v8, v10
    s_nop 1
    v_permlane32_swap_b32 v10, v8
    v_max_f32 v10, v10, v8
    v_sub_f32 v32, v32, v10
    v_mul_f32 v32, s44, v32
    v_exp_f32 v32, v32
    v_sub_f32 v33, v33, v10
    v_mul_f32 v33, s44, v33
    v_exp_f32 v33, v33
    v_sub_f32 v34, v34, v10
    v_mul_f32 v34, s44, v34
    v_exp_f32 v34, v34
    v_sub_f32 v35, v35, v10
    v_mul_f32 v35, s44, v35
    v_exp_f32 v35, v35
    v_sub_f32 v36, v36, v10
    v_mul_f32 v36, s44, v36
    v_exp_f32 v36, v36
    v_sub_f32 v37, v37, v10
    v_mul_f32 v37, s44, v37
    v_exp_f32 v37, v37
    v_sub_f32 v38, v38, v10
    v_mul_f32 v38, s44, v38
    v_exp_f32 v38, v38
    v_sub_f32 v39, v39, v10
    v_mul_f32 v39, s44, v39
    v_exp_f32 v39, v39
    v_sub_f32 v40, v40, v10
    v_mul_f32 v40, s44, v40
    v_exp_f32 v40, v40
    v_sub_f32 v41, v41, v10
    v_mul_f32 v41, s44, v41
    v_exp_f32 v41, v41
    v_sub_f32 v42, v42, v10
    v_mul_f32 v42, s44, v42
    v_exp_f32 v42, v42
    v_sub_f32 v43, v43, v10
    v_mul_f32 v43, s44, v43
    v_exp_f32 v43, v43
    v_sub_f32 v44, v44, v10
    v_mul_f32 v44, s44, v44
    v_exp_f32 v44, v44
    v_sub_f32 v45, v45, v10
    v_mul_f32 v45, s44, v45
    v_exp_f32 v45, v45
    v_sub_f32 v46, v46, v10
    v_mul_f32 v46, s44, v46
    v_exp_f32 v46, v46
    v_sub_f32 v47, v47, v10
    v_mul_f32 v47, s44, v47
    v_exp_f32 v47, v47
    v_sub_f32 v48, v48, v10
    v_mul_f32 v48, s44, v48
    v_exp_f32 v48, v48
    v_sub_f32 v49, v49, v10
    v_mul_f32 v49, s44, v49
    v_exp_f32 v49, v49
    v_sub_f32 v50, v50, v10
    v_mul_f32 v50, s44, v50
    v_exp_f32 v50, v50
    v_sub_f32 v51, v51, v10
    v_mul_f32 v51, s44, v51
    v_exp_f32 v51, v51
    v_sub_f32 v52, v52, v10
    v_mul_f32 v52, s44, v52
    v_exp_f32 v52, v52
    v_sub_f32 v53, v53, v10
    v_mul_f32 v53, s44, v53
    v_exp_f32 v53, v53
    v_sub_f32 v54, v54, v10
    v_mul_f32 v54, s44, v54
    v_exp_f32 v54, v54
    v_sub_f32 v55, v55, v10
    v_mul_f32 v55, s44, v55
    v_exp_f32 v55, v55
    v_sub_f32 v56, v56, v10
    v_mul_f32 v56, s44, v56
    v_exp_f32 v56, v56
    v_sub_f32 v57, v57, v10
    v_mul_f32 v57, s44, v57
    v_exp_f32 v57, v57
    v_sub_f32 v58, v58, v10
    v_mul_f32 v58, s44, v58
    v_exp_f32 v58, v58
    v_sub_f32 v59, v59, v10
    v_mul_f32 v59, s44, v59
    v_exp_f32 v59, v59
    v_sub_f32 v60, v60, v10
    v_mul_f32 v60, s44, v60
    v_exp_f32 v60, v60
    v_sub_f32 v61, v61, v10
    v_mul_f32 v61, s44, v61
    v_exp_f32 v61, v61
    v_sub_f32 v62, v62, v10
    v_mul_f32 v62, s44, v62
    v_exp_f32 v62, v62
    v_sub_f32 v63, v63, v10
    v_mul_f32 v63, s44, v63
    v_exp_f32 v63, v63
    s_nop 0
    v_add_f32 v11, v32, v33
    v_add_f32 v11, v11, v34
    v_add_f32 v11, v11, v35
    v_add_f32 v11, v11, v36
    v_add_f32 v11, v11, v37
    v_add_f32 v11, v11, v38
    v_add_f32 v11, v11, v39
    v_add_f32 v11, v11, v40
    v_add_f32 v11, v11, v41
    v_add_f32 v11, v11, v42
    v_add_f32 v11, v11, v43
    v_add_f32 v11, v11, v44
    v_add_f32 v11, v11, v45
    v_add_f32 v11, v11, v46
    v_add_f32 v11, v11, v47
    v_add_f32 v11, v11, v48
    v_add_f32 v11, v11, v49
    v_add_f32 v11, v11, v50
    v_add_f32 v11, v11, v51
    v_add_f32 v11, v11, v52
    v_add_f32 v11, v11, v53
    v_add_f32 v11, v11, v54
    v_add_f32 v11, v11, v55
    v_add_f32 v11, v11, v56
    v_add_f32 v11, v11, v57
    v_add_f32 v11, v11, v58
    v_add_f32 v11, v11, v59
    v_add_f32 v11, v11, v60
    v_add_f32 v11, v11, v61
    v_add_f32 v11, v11, v62
    v_add_f32 v11, v11, v63
    v_mov_b32 v8, v11
    s_nop 1
    v_permlane16_swap_b32 v11, v8
    v_add_f32 v11, v11, v8
    v_mov_b32 v8, v11
    s_nop 1
    v_permlane32_swap_b32 v11, v8
    v_add_f32 v11, v11, v8
    v_cvt_pk_bf16_f32 v16, v32, v33
    v_cvt_pk_bf16_f32 v17, v34, v35
    v_cvt_pk_bf16_f32 v18, v36, v37
    v_cvt_pk_bf16_f32 v19, v38, v39
    v_cvt_pk_bf16_f32 v20, v40, v41
    v_cvt_pk_bf16_f32 v21, v42, v43
    v_cvt_pk_bf16_f32 v22, v44, v45
    v_cvt_pk_bf16_f32 v23, v46, v47
    v_cvt_pk_bf16_f32 v24, v48, v49
    v_cvt_pk_bf16_f32 v25, v50, v51
    v_cvt_pk_bf16_f32 v26, v52, v53
    v_cvt_pk_bf16_f32 v27, v54, v55
    v_cvt_pk_bf16_f32 v28, v56, v57
    v_cvt_pk_bf16_f32 v29, v58, v59
    v_cvt_pk_bf16_f32 v30, v60, v61
    v_cvt_pk_bf16_f32 v31, v62, v63
    s_setpc_b64 s[94:95]
L_qk_done:
    s_waitcnt vmcnt(24)
    v_perm_b32 v64, v132, v128, s37
    v_perm_b32 v65, v140, v136, s37
    v_perm_b32 v66, v148, v144, s37
    v_perm_b32 v67, v156, v152, s37
    v_perm_b32 v68, v132, v128, s38
    v_perm_b32 v69, v140, v136, s38
    v_perm_b32 v70, v148, v144, s38
    v_perm_b32 v71, v156, v152, s38
    v_perm_b32 v72, v133, v129, s37
    v_perm_b32 v73, v141, v137, s37
    v_perm_b32 v74, v149, v145, s37
    v_perm_b32 v75, v157, v153, s37
    v_perm_b32 v76, v133, v129, s38
    v_perm_b32 v77, v141, v137, s38
    v_perm_b32 v78, v149, v145, s38
    v_perm_b32 v79, v157, v153, s38
    v_perm_b32 v80, v134, v130, s37
    v_perm_b32 v81, v142, v138, s37
    v_perm_b32 v82, v150, v146, s37
    v_perm_b32 v83, v158, v154, s37
    v_perm_b32 v84, v134, v130, s38
    v_perm_b32 v85, v142, v138, s38
    v_perm_b32 v86, v150, v146, s38
    v_perm_b32 v87, v158, v154, s38
    v_perm_b32 v88, v135, v131, s37
    v_perm_b32 v89, v143, v139, s37
    v_perm_b32 v90, v151, v147, s37
    v_perm_b32 v91, v159, v155, s37
    v_perm_b32 v92, v135, v131, s38
    v_perm_b32 v93, v143, v139, s38
    v_perm_b32 v94, v151, v147, s38
    v_perm_b32 v95, v159, v155, s38
    s_nop 1
    v_mfma_f32_16x16x32_bf16 v[96:99], v[16:19], v[64:67], 0
    v_mfma_f32_16x16x32_bf16 v[100:103], v[16:19], v[68:71], 0
    v_mfma_f32_16x16x32_bf16 v[104:107], v[16:19], v[72:75], 0
    v_mfma_f32_16x16x32_bf16 v[108:111], v[16:19], v[76:79], 0
    v_mfma_f32_16x16x32_bf16 v[112:115], v[16:19], v[80:83], 0
    v_mfma_f32_16x16x32_bf16 v[116:119], v[16:19], v[84:87], 0
    v_mfma_f32_16x16x32_bf16 v[120:123], v[16:19], v[88:91], 0
    v_mfma_f32_16x16x32_bf16 v[124:127], v[16:19], v[92:95], 0
    s_waitcnt vmcnt(16)
    v_perm_b32 v64, v164, v160, s37
    v_perm_b32 v65, v172, v168, s37
    v_perm_b32 v66, v180, v176, s37
    v_perm_b32 v67, v188, v184, s37
    v_perm_b32 v68, v164, v160, s38
    v_perm_b32 v69, v172, v168, s38
    v_perm_b32 v70, v180, v176, s38
    v_perm_b32 v71, v188, v184, s38
    v_perm_b32 v72, v165, v161, s37
    v_perm_b32 v73, v173, v169, s37
    v_perm_b32 v74, v181, v177, s37
    v_perm_b32 v75, v189, v185, s37
    v_perm_b32 v76, v165, v161, s38
    v_perm_b32 v77, v173, v169, s38
    v_perm_b32 v78, v181, v177, s38
    v_perm_b32 v79, v189, v185, s38
    v_perm_b32 v80, v166, v162, s37
    v_perm_b32 v81, v174, v170, s37
    v_perm_b32 v82, v182, v178, s37
    v_perm_b32 v83, v190, v186, s37
    v_perm_b32 v84, v166, v162, s38
    v_perm_b32 v85, v174, v170, s38
    v_perm_b32 v86, v182, v178, s38
    v_perm_b32 v87, v190, v186, s38
    v_perm_b32 v88, v167, v163, s37
    v_perm_b32 v89, v175, v171, s37
    v_perm_b32 v90, v183, v179, s37
    v_perm_b32 v91, v191, v187, s37
    v_perm_b32 v92, v167, v163, s38
    v_perm_b32 v93, v175, v171, s38
    v_perm_b32 v94, v183, v179, s38
    v_perm_b32 v95, v191, v187, s38
    s_nop 1
    v_mfma_f32_16x16x32_bf16 v[96:99], v[20:23], v[64:67], v[96:99]
    v_mfma_f32_16x16x32_bf16 v[100:103], v[20:23], v[68:71], v[100:103]
    v_mfma_f32_16x16x32_bf16 v[104:107], v[20:23], v[72:75], v[104:107]
    v_mfma_f32_16x16x32_bf16 v[108:111], v[20:23], v[76:79], v[108:111]
    v_mfma_f32_16x16x32_bf16 v[112:115], v[20:23], v[80:83], v[112:115]
    v_mfma_f32_16x16x32_bf16 v[116:119], v[20:23], v[84:87], v[116:119]
    v_mfma_f32_16x16x32_bf16 v[120:123], v[20:23], v[88:91], v[120:123]
    v_mfma_f32_16x16x32_bf16 v[124:127], v[20:23], v[92:95], v[124:127]
    s_waitcnt vmcnt(8)
    v_perm_b32 v64, v196, v192, s37
    v_perm_b32 v65, v204, v200, s37
    v_perm_b32 v66, v212, v208, s37
    v_perm_b32 v67, v220, v216, s37
    v_perm_b32 v68, v196, v192, s38
    v_perm_b32 v69, v204, v200, s38
    v_perm_b32 v70, v212, v208, s38
    v_perm_b32 v71, v220, v216, s38
    v_perm_b32 v72, v197, v193, s37
    v_perm_b32 v73, v205, v201, s37
    v_perm_b32 v74, v213, v209, s37
    v_perm_b32 v75, v221, v217, s37
    v_perm_b32 v76, v197, v193, s38
    v_perm_b32 v77, v205, v201, s38
    v_perm_b32 v78, v213, v209, s38
    v_perm_b32 v79, v221, v217, s38
    v_perm_b32 v80, v198, v194, s37
    v_perm_b32 v81, v206, v202, s37
    v_perm_b32 v82, v214, v210, s37
    v_perm_b32 v83, v222, v218, s37
    v_perm_b32 v84, v198, v194, s38
    v_perm_b32 v85, v206, v202, s38
    v_perm_b32 v86, v214, v210, s38
    v_perm_b32 v87, v222, v218, s38
    v_perm_b32 v88, v199, v195, s37
    v_perm_b32 v89, v207, v203, s37
    v_perm_b32 v90, v215, v211, s37
    v_perm_b32 v91, v223, v219, s37
    v_perm_b32 v92, v199, v195, s38
    v_perm_b32 v93, v207, v203, s38
    v_perm_b32 v94, v215, v211, s38
    v_perm_b32 v95, v223, v219, s38
    s_nop 1
    v_mfma_f32_16x16x32_bf16 v[96:99], v[24:27], v[64:67], v[96:99]
    v_mfma_f32_16x16x32_bf16 v[100:103], v[24:27], v[68:71], v[100:103]
    v_mfma_f32_16x16x32_bf16 v[104:107], v[24:27], v[72:75], v[104:107]
    v_mfma_f32_16x16x32_bf16 v[108:111], v[24:27], v[76:79], v[108:111]
    v_mfma_f32_16x16x32_bf16 v[112:115], v[24:27], v[80:83], v[112:115]
    v_mfma_f32_16x16x32_bf16 v[116:119], v[24:27], v[84:87], v[116:119]
    v_mfma_f32_16x16x32_bf16 v[120:123], v[24:27], v[88:91], v[120:123]
    v_mfma_f32_16x16x32_bf16 v[124:127], v[24:27], v[92:95], v[124:127]
    s_waitcnt vmcnt(0)
    v_perm_b32 v64, v228, v224, s37
    v_perm_b32 v65, v236, v232, s37
    v_perm_b32 v66, v244, v240, s37
    v_perm_b32 v67, v252, v248, s37
    v_perm_b32 v68, v228, v224, s38
    v_perm_b32 v69, v236, v232, s38
    v_perm_b32 v70, v244, v240, s38
    v_perm_b32 v71, v252, v248, s38
    v_perm_b32 v72, v229, v225, s37
    v_perm_b32 v73, v237, v233, s37
    v_perm_b32 v74, v245, v241, s37
    v_perm_b32 v75, v253, v249, s37
    v_perm_b32 v76, v229, v225, s38
    v_perm_b32 v77, v237, v233, s38
    v_perm_b32 v78, v245, v241, s38
    v_perm_b32 v79, v253, v249, s38
    v_perm_b32 v80, v230, v226, s37
    v_perm_b32 v81, v238, v234, s37
    v_perm_b32 v82, v246, v242, s37
    v_perm_b32 v83, v254, v250, s37
    v_perm_b32 v84, v230, v226, s38
    v_perm_b32 v85, v238, v234, s38
    v_perm_b32 v86, v246, v242, s38
    v_perm_b32 v87, v254, v250, s38
    v_perm_b32 v88, v231, v227, s37
    v_perm_b32 v89, v239, v235, s37
    v_perm_b32 v90, v247, v243, s37
    v_perm_b32 v91, v255, v251, s37
    v_perm_b32 v92, v231, v227, s38
    v_perm_b32 v93, v239, v235, s38
    v_perm_b32 v94, v247, v243, s38
    v_perm_b32 v95, v255, v251, s38
    s_nop 1
    v_mfma_f32_16x16x32_bf16 v[96:99], v[28:31], v[64:67], v[96:99]
    v_mfma_f32_16x16x32_bf16 v[100:103], v[28:31], v[68:71], v[100:103]
    v_mfma_f32_16x16x32_bf16 v[104:107], v[28:31], v[72:75], v[104:107]
    v_mfma_f32_16x16x32_bf16 v[108:111], v[28:31], v[76:79], v[108:111]
    v_mfma_f32_16x16x32_bf16 v[112:115], v[28:31], v[80:83], v[112:115]
    v_mfma_f32_16x16x32_bf16 v[116:119], v[28:31], v[84:87], v[116:119]
    v_mfma_f32_16x16x32_bf16 v[120:123], v[28:31], v[88:91], v[120:123]
    v_mfma_f32_16x16x32_bf16 v[124:127], v[28:31], v[92:95], v[124:127]
    s_lshl_b32 s52, s34, 10
    v_lshlrev_b32 v8, 5, v3
    v_add_u32 v8, s52, v8
    s_lshl_b32 s52, s34, 4
    v_lshlrev_b32 v9, 3, v1
    v_add_u32 v9, s52, v9
    s_nop 5
    v_mov_b32 v32, v96
    v_mov_b32 v33, v100
    v_mov_b32 v34, v104
    v_mov_b32 v35, v108
    v_mov_b32 v36, v112
    v_mov_b32 v37, v116
    v_mov_b32 v38, v120
    v_mov_b32 v39, v124
    v_mov_b32 v40, v97
    v_mov_b32 v41, v101
    v_mov_b32 v42, v105
    v_mov_b32 v43, v109
    v_mov_b32 v44, v113
    v_mov_b32 v45, v117
    v_mov_b32 v46, v121
    v_mov_b32 v47, v125
    s_mov_b64 exec, 0xffff
    ds_write_b128 v8, v[32:35] offset:8192
    ds_write_b128 v8, v[36:39] offset:8208
    ds_write_b128 v8, v[40:43] offset:8704
    ds_write_b128 v8, v[44:47] offset:8720
    s_mov_b64 exec, 3
    ds_write_b64 v9, v[10:11] offset:1024
    s_mov_b64 exec, 1
    v_mov_b32 v8, 1
    s_waitcnt lgkmcnt(0)
    ds_add_rtn_u32 v8, v7, v8 offset:8
    s_waitcnt lgkmcnt(0)
    v_readfirstlane_b32 s52, v8
    s_mov_b64 exec, -1
    s_cmp_lg_u32 s52, 3
    s_cbranch_scc1 L_end
    v_lshrrev_b32 v12, 5, v1
    v_and_b32 v13, 31, v1
    v_lshlrev_b32 v8, 4, v1
    v_lshlrev_b32 v9, 3, v12
    ds_read_b128 v[32:35], v8 offset:8192
    ds_read_b64 v[48:49], v9 offset:1024
    ds_read_b128 v[36:39], v8 offset:9216
    ds_read_b64 v[50:51], v9 offset:1040
    ds_read_b128 v[40:43], v8 offset:10240
    ds_read_b64 v[52:53], v9 offset:1056
    ds_read_b128 v[44:47], v8 offset:11264
    ds_read_b64 v[54:55], v9 offset:1072
    s_lshl_b32 s53, s32, 5
    s_add_u32 s53, s53, s33
    s_mul_i32 s53, s53, 1280
    s_add_u32 s53, s53, 1048576
    s_add_u32 s40, s30, s53
    s_addc_u32 s41, s31, 0
    s_waitcnt lgkmcnt(0)
    v_max3_f32 v10, v48, v50, v52
    v_max_f32 v10, v10, v54
    v_sub_f32 v48, v48, v10
    v_mul_f32 v48, s44, v48
    v_exp_f32 v48, v48
    v_sub_f32 v50, v50, v10
    v_mul_f32 v50, s44, v50
    v_exp_f32 v50, v50
    v_sub_f32 v52, v52, v10
    v_mul_f32 v52, s44, v52
    v_exp_f32 v52, v52
    v_sub_f32 v54, v54, v10
    v_mul_f32 v54, s44, v54
    v_exp_f32 v54, v54
    s_nop 0
    v_mul_f32 v11, v48, v49
    v_fmac_f32 v11, v50, v51
    v_fmac_f32 v11, v52, v53
    v_fmac_f32 v11, v54, v55
    v_mul_f32 v56, v48, v32
    v_fmac_f32 v56, v50, v36
    v_fmac_f32 v56, v52, v40
    v_fmac_f32 v56, v54, v44
    v_mul_f32 v57, v48, v33
    v_fmac_f32 v57, v50, v37
    v_fmac_f32 v57, v52, v41
    v_fmac_f32 v57, v54, v45
    v_mul_f32 v58, v48, v34
    v_fmac_f32 v58, v50, v38
    v_fmac_f32 v58, v52, v42
    v_fmac_f32 v58, v54, v46
    v_mul_f32 v59, v48, v35
    v_fmac_f32 v59, v50, v39
    v_fmac_f32 v59, v52, v43
    v_fmac_f32 v59, v54, v47
    s_mov_b32 s45, 3200000
L_lw_10:
    ds_read_b32 v8, v7 offset:12
    s_waitcnt lgkmcnt(0)
    v_readfirstlane_b32 s52, v8
    s_cmp_lg_u32 s52, 0
    s_cbranch_scc1 L_lwd_11
    s_sleep 1
    s_sub_u32 s45, s45, 1
    s_cmp_lg_u32 s45, 0
    s_cbranch_scc1 L_lw_10
L_lwd_11:
    ds_read_b32 v8, v7 offset:24
    s_waitcnt lgkmcnt(0)
    v_readfirstlane_b32 s46, v8
    s_nop 1
    v_mov_b32 v64, v56
    v_mov_b32 v65, s46
    v_mov_b32 v66, v57
    v_mov_b32 v67, s46
    v_mov_b32 v68, v58
    v_mov_b32 v69, s46
    v_mov_b32 v70, v59
    v_mov_b32 v71, s46
    v_mov_b32 v72, v10
    v_mov_b32 v73, s46
    v_mov_b32 v74, v11
    v_mov_b32 v75, s46
    v_mul_u32_u24 v8, 20480, v12
    v_lshl_add_u32 v9, v13, 5, v8
    global_store_dwordx4 v9, v[64:67], s[40:41] sc1
    global_store_dwordx4 v9, v[68:71], s[40:41] offset:16 sc1
    s_mov_b32 exec_lo, 1
    s_mov_b32 exec_hi, 1
    global_store_dwordx4 v8, v[72:75], s[40:41] offset:1024 sc1
    s_mov_b64 exec, 1
    v_mov_b32 v10, 1
    s_waitcnt lgkmcnt(0)
    ds_add_u32 v7, v10 offset:28
    s_mov_b64 exec, -1
    s_branch L_end
L_aux:
    s_setprio 3
    s_sub_u32 s47, s34, 4
    v_lshrrev_b32 v5, 5, v1
    v_and_b32 v6, 31, v1
    s_lshr_b32 s50, s33, 2
    s_and_b32 s51, s33, 3
    s_cmp_eq_u32 s47, 3
    s_cbranch_scc1 L_x3
    v_lshlrev_b32 v9, 1, v1
    global_load_ushort v20, v9, s[8:9] offset:0
    global_load_ushort v21, v9, s[8:9] offset:128
    global_load_ushort v22, v9, s[8:9] offset:256
    global_load_ushort v23, v9, s[8:9] offset:384
    global_load_ushort v24, v9, s[8:9] offset:512
    global_load_ushort v25, v9, s[8:9] offset:640
    global_load_ushort v26, v9, s[8:9] offset:768
    global_load_ushort v27, v9, s[8:9] offset:896
    global_load_ushort v28, v9, s[8:9] offset:1024
    s_mul_i32 s56, s50, 144
    s_cmp_lg_u32 s47, 0
    s_cbranch_scc1 L_s1_gu
    v_lshrrev_b32 v14, 3, v1
    v_and_b32 v15, 7, v1
    v_lshlrev_b32 v16, 13, v14
    v_lshl_add_u32 v16, v15, 4, v16
    s_lshl_b32 s53, s56, 13
    s_lshl_b32 s54, s32, 9
    s_add_u32 s53, s53, s54
    s_lshl_b32 s54, s51, 7
    s_add_u32 s53, s53, s54
    s_add_u32 s40, s14, s53
    s_addc_u32 s41, s15, 0
    global_load_dwordx4 v[128:131], v16, s[40:41] nt
    s_add_u32 s40, s40, 65536
    s_addc_u32 s41, s41, 0
    global_load_dwordx4 v[132:135], v16, s[40:41] nt
    s_add_u32 s40, s40, 65536
    s_addc_u32 s41, s41, 0
    global_load_dwordx4 v[136:139], v16, s[40:41] nt
    s_add_u32 s40, s40, 65536
    s_addc_u32 s41, s41, 0
    global_load_dwordx4 v[140:143], v16, s[40:41] nt
    s_add_u32 s40, s40, 65536
    s_addc_u32 s41, s41, 0
    global_load_dwordx4 v[144:147], v16, s[40:41] nt
    s_add_u32 s40, s40, 65536
    s_addc_u32 s41, s41, 0
    global_load_dwordx4 v[148:151], v16, s[40:41] nt
    s_add_u32 s40, s40, 65536
    s_addc_u32 s41, s41, 0
    global_load_dwordx4 v[152:155], v16, s[40:41] nt
    s_add_u32 s40, s40, 65536
    s_addc_u32 s41, s41, 0
    global_load_dwordx4 v[156:159], v16, s[40:41] nt
    s_add_u32 s40, s40, 65536
    s_addc_u32 s41, s41, 0
    global_load_dwordx4 v[160:163], v16, s[40:41] nt
    s_add_u32 s40, s40, 65536
    s_addc_u32 s41, s41, 0
    global_load_dwordx4 v[164:167], v16, s[40:41] nt
    s_add_u32 s40, s40, 65536
    s_addc_u32 s41, s41, 0
    global_load_dwordx4 v[168:171], v16, s[40:41] nt
    s_add_u32 s40, s40, 65536
    s_addc_u32 s41, s41, 0
    global_load_dwordx4 v[172:175], v16, s[40:41] nt
    s_add_u32 s40, s40, 65536
    s_addc_u32 s41, s41, 0
    global_load_dwordx4 v[176:179], v16, s[40:41] nt
    s_add_u32 s40, s40, 65536
    s_addc_u32 s41, s41, 0
    global_load_dwordx4 v[180:183], v16, s[40:41] nt
    s_add_u32 s40, s40, 65536
    s_addc_u32 s41, s41, 0
    global_load_dwordx4 v[184:187], v16, s[40:41] nt
    s_add_u32 s40, s40, 65536
    s_addc_u32 s41, s41, 0
    global_load_dwordx4 v[188:191], v16, s[40:41] nt
    s_add_u32 s40, s40, 65536
    s_addc_u32 s41, s41, 0
    global_load_dwordx4 v[192:195], v16, s[40:41] nt
    s_add_u32 s40, s40, 65536
    s_addc_u32 s41, s41, 0
    global_load_dwordx4 v[196:199], v16, s[40:41] nt
    s_branch L_s1_issued
L_s1_gu:
    s_mov_b32 s53, 0x1c72
    v_mul_u32_u24 v14, s53, v1
    v_lshrrev_b32 v14, 16, v14
    v_mul_u32_u24 v15, 9, v14
    v_sub_u32 v15, v1, v15
    v_min_u32 v14, 6, v14
    v_mul_u32_u24 v16, 9216, v14
    v_lshl_add_u32 v16, v15, 4, v16
    v_min_u32 v8, 3, v14
    v_mul_u32_u24 v8, 9216, v8
    v_lshl_add_u32 v8, v15, 4, v8
    s_mul_i32 s53, s56, 9216
    s_mul_i32 s54, s32, 576
    s_add_u32 s53, s53, s54
    s_mul_i32 s54, s51, 144
    s_add_u32 s53, s53, s54
    s_cmp_eq_u32 s47, 1
    s_cselect_b32 s40, s20, s22
    s_cselect_b32 s41, s21, s23
    s_add_u32 s40, s40, s53
    s_addc_u32 s41, s41, 0
    global_load_dwordx4 v[128:131], v16, s[40:41] nt
    s_add_u32 s40, s40, 64512
    s_addc_u32 s41, s41, 0
    global_load_dwordx4 v[132:135], v16, s[40:41] nt
    s_add_u32 s40, s40, 64512
    s_addc_u32 s41, s41, 0
    global_load_dwordx4 v[136:139], v16, s[40:41] nt
    s_add_u32 s40, s40, 64512
    s_addc_u32 s41, s41, 0
    global_load_dwordx4 v[140:143], v16, s[40:41] nt
    s_add_u32 s40, s40, 64512
    s_addc_u32 s41, s41, 0
    global_load_dwordx4 v[144:147], v16, s[40:41] nt
    s_add_u32 s40, s40, 64512
    s_addc_u32 s41, s41, 0
    global_load_dwordx4 v[148:151], v16, s[40:41] nt
    s_add_u32 s40, s40, 64512
    s_addc_u32 s41, s41, 0
    global_load_dwordx4 v[152:155], v16, s[40:41] nt
    s_add_u32 s40, s40, 64512
    s_addc_u32 s41, s41, 0
    global_load_dwordx4 v[156:159], v16, s[40:41] nt
    s_add_u32 s40, s40, 64512
    s_addc_u32 s41, s41, 0
    global_load_dwordx4 v[160:163], v16, s[40:41] nt
    s_add_u32 s40, s40, 64512
    s_addc_u32 s41, s41, 0
    global_load_dwordx4 v[164:167], v16, s[40:41] nt
    s_add_u32 s40, s40, 64512
    s_addc_u32 s41, s41, 0
    global_load_dwordx4 v[168:171], v16, s[40:41] nt
    s_add_u32 s40, s40, 64512
    s_addc_u32 s41, s41, 0
    global_load_dwordx4 v[172:175], v16, s[40:41] nt
    s_add_u32 s40, s40, 64512
    s_addc_u32 s41, s41, 0
    global_load_dwordx4 v[176:179], v16, s[40:41] nt
    s_add_u32 s40, s40, 64512
    s_addc_u32 s41, s41, 0
    global_load_dwordx4 v[180:183], v16, s[40:41] nt
    s_add_u32 s40, s40, 64512
    s_addc_u32 s41, s41, 0
    global_load_dwordx4 v[184:187], v16, s[40:41] nt
    s_add_u32 s40, s40, 64512
    s_addc_u32 s41, s41, 0
    global_load_dwordx4 v[188:191], v16, s[40:41] nt
    s_add_u32 s40, s40, 64512
    s_addc_u32 s41, s41, 0
    global_load_dwordx4 v[192:195], v16, s[40:41] nt
    s_add_u32 s40, s40, 64512
    s_addc_u32 s41, s41, 0
    global_load_dwordx4 v[196:199], v16, s[40:41] nt
    s_add_u32 s40, s40, 64512
    s_addc_u32 s41, s41, 0
    global_load_dwordx4 v[200:203], v16, s[40:41] nt
    s_add_u32 s40, s40, 64512
    s_addc_u32 s41, s41, 0
    global_load_dwordx4 v[204:207], v16, s[40:41] nt
    s_add_u32 s40, s40, 64512
    s_addc_u32 s41, s41, 0
    global_load_dwordx4 v[208:211], v8, s[40:41] nt
L_s1_issued:
    s_mov_b64 exec, 1
    v_mov_b32 v8, 1
    s_waitcnt lgkmcnt(0)
    ds_add_u32 v7, v8 offset:20
    s_mov_b64 exec, -1
    s_waitcnt vmcnt(18)
    v_lshlrev_b32 v20, 16, v20
    v_lshlrev_b32 v21, 16, v21
    v_lshlrev_b32 v22, 16, v22
    v_lshlrev_b32 v23, 16, v23
    v_lshlrev_b32 v24, 16, v24
    v_lshlrev_b32 v25, 16, v25
    v_lshlrev_b32 v26, 16, v26
    v_lshlrev_b32 v27, 16, v27
    v_lshlrev_b32 v28, 16, v28
    v_add_f32 v29, v20, v21
    v_add_f32 v29, v29, v22
    v_add_f32 v29, v29, v23
    v_add_f32 v29, v29, v24
    v_add_f32 v29, v29, v25
    v_add_f32 v29, v29, v26
    v_add_f32 v29, v29, v27
    v_add_f32 v29, v29, v28
    s_nop 1
    v_add_f32_dpp v29, v29, v29 quad_perm:[1,0,3,2] row_mask:0xf bank_mask:0xf
    s_nop 1
    v_add_f32_dpp v29, v29, v29 quad_perm:[2,3,0,1] row_mask:0xf bank_mask:0xf
    s_nop 1
    v_add_f32_dpp v29, v29, v29 row_half_mirror row_mask:0xf bank_mask:0xf
    s_nop 1
    v_add_f32_dpp v29, v29, v29 row_mirror row_mask:0xf bank_mask:0xf
    v_mov_b32 v8, v29
    s_nop 1
    v_permlane16_swap_b32 v29, v8
    v_add_f32 v29, v29, v8
    v_mov_b32 v8, v29
    s_nop 1
    v_permlane32_swap_b32 v29, v8
    v_add_f32 v29, v29, v8
    v_mul_f32 v30, 0x3ae38e39, v29
    v_sub_f32 v52, v20, v30
    v_sub_f32 v53, v21, v30
    v_sub_f32 v54, v22, v30
    v_sub_f32 v55, v23, v30
    v_sub_f32 v56, v24, v30
    v_sub_f32 v57, v25, v30
    v_sub_f32 v58, v26, v30
    v_sub_f32 v59, v27, v30
    v_sub_f32 v60, v28, v30
    v_mul_f32 v29, v52, v52
    v_fmac_f32 v29, v53, v53
    v_fmac_f32 v29, v54, v54
    v_fmac_f32 v29, v55, v55
    v_fmac_f32 v29, v56, v56
    v_fmac_f32 v29, v57, v57
    v_fmac_f32 v29, v58, v58
    v_fmac_f32 v29, v59, v59
    v_fmac_f32 v29, v60, v60
    s_nop 1
    v_add_f32_dpp v29, v29, v29 quad_perm:[1,0,3,2] row_mask:0xf bank_mask:0xf
    s_nop 1
    v_add_f32_dpp v29, v29, v29 quad_perm:[2,3,0,1] row_mask:0xf bank_mask:0xf
    s_nop 1
    v_add_f32_dpp v29, v29, v29 row_half_mirror row_mask:0xf bank_mask:0xf
    s_nop 1
    v_add_f32_dpp v29, v29, v29 row_mirror row_mask:0xf bank_mask:0xf
    v_mov_b32 v8, v29
    s_nop 1
    v_permlane16_swap_b32 v29, v8
    v_add_f32 v29, v29, v8
    v_mov_b32 v8, v29
    s_nop 1
    v_permlane32_swap_b32 v29, v8
    v_add_f32 v29, v29, v8
    v_mul_f32 v29, 0x3ae38e39, v29
    v_cvt_pk_bf16_f32 v29, v29, v29
    v_lshlrev_b32 v29, 16, v29
    v_add_f32 v29, 0x3727c5ac, v29
    v_cvt_pk_bf16_f32 v29, v29, v29
    v_lshlrev_b32 v29, 16, v29
    v_sqrt_f32 v18, v29
    s_nop 0
    v_cvt_pk_bf16_f32 v18, v18, v18
    v_lshlrev_b32 v18, 16, v18
    v_rcp_f32 v17, v18
    v_cvt_pk_bf16_f32 v30, v30, v30
    v_lshlrev_b32 v30, 16, v30
    v_lshlrev_b32 v10, 2, v1
    v_sub_f32 v20, v20, v30
    v_cvt_pk_bf16_f32 v20, v20, v20
    v_lshlrev_b32 v20, 16, v20
    v_mul_f32 v8, v20, v17
    v_fma_f32 v9, -v8, v18, v20
    v_fma_f32 v20, v9, v17, v8
    v_cvt_pk_bf16_f32 v20, v20, v20
    v_lshlrev_b32 v20, 16, v20
    ds_write_b32 v10, v20 offset:2816
    v_sub_f32 v21, v21, v30
    v_cvt_pk_bf16_f32 v21, v21, v21
    v_lshlrev_b32 v21, 16, v21
    v_mul_f32 v8, v21, v17
    v_fma_f32 v9, -v8, v18, v21
    v_fma_f32 v21, v9, v17, v8
    v_cvt_pk_bf16_f32 v21, v21, v21
    v_lshlrev_b32 v21, 16, v21
    ds_write_b32 v10, v21 offset:3072
    v_sub_f32 v22, v22, v30
    v_cvt_pk_bf16_f32 v22, v22, v22
    v_lshlrev_b32 v22, 16, v22
    v_mul_f32 v8, v22, v17
    v_fma_f32 v9, -v8, v18, v22
    v_fma_f32 v22, v9, v17, v8
    v_cvt_pk_bf16_f32 v22, v22, v22
    v_lshlrev_b32 v22, 16, v22
    ds_write_b32 v10, v22 offset:3328
    v_sub_f32 v23, v23, v30
    v_cvt_pk_bf16_f32 v23, v23, v23
    v_lshlrev_b32 v23, 16, v23
    v_mul_f32 v8, v23, v17
    v_fma_f32 v9, -v8, v18, v23
    v_fma_f32 v23, v9, v17, v8
    v_cvt_pk_bf16_f32 v23, v23, v23
    v_lshlrev_b32 v23, 16, v23
    ds_write_b32 v10, v23 offset:3584
    v_sub_f32 v24, v24, v30
    v_cvt_pk_bf16_f32 v24, v24, v24
    v_lshlrev_b32 v24, 16, v24
    v_mul_f32 v8, v24, v17
    v_fma_f32 v9, -v8, v18, v24
    v_fma_f32 v24, v9, v17, v8
    v_cvt_pk_bf16_f32 v24, v24, v24
    v_lshlrev_b32 v24, 16, v24
    ds_write_b32 v10, v24 offset:3840
    v_sub_f32 v25, v25, v30
    v_cvt_pk_bf16_f32 v25, v25, v25
    v_lshlrev_b32 v25, 16, v25
    v_mul_f32 v8, v25, v17
    v_fma_f32 v9, -v8, v18, v25
    v_fma_f32 v25, v9, v17, v8
    v_cvt_pk_bf16_f32 v25, v25, v25
    v_lshlrev_b32 v25, 16, v25
    ds_write_b32 v10, v25 offset:4096
    v_sub_f32 v26, v26, v30
    v_cvt_pk_bf16_f32 v26, v26, v26
    v_lshlrev_b32 v26, 16, v26
    v_mul_f32 v8, v26, v17
    v_fma_f32 v9, -v8, v18, v26
    v_fma_f32 v26, v9, v17, v8
    v_cvt_pk_bf16_f32 v26, v26, v26
    v_lshlrev_b32 v26, 16, v26
    ds_write_b32 v10, v26 offset:4352
    v_sub_f32 v27, v27, v30
    v_cvt_pk_bf16_f32 v27, v27, v27
    v_lshlrev_b32 v27, 16, v27
    v_mul_f32 v8, v27, v17
    v_fma_f32 v9, -v8, v18, v27
    v_fma_f32 v27, v9, v17, v8
    v_cvt_pk_bf16_f32 v27, v27, v27
    v_lshlrev_b32 v27, 16, v27
    ds_write_b32 v10, v27 offset:4608
    v_sub_f32 v28, v28, v30
    v_cvt_pk_bf16_f32 v28, v28, v28
    v_lshlrev_b32 v28, 16, v28
    v_mul_f32 v8, v28, v17
    v_fma_f32 v9, -v8, v18, v28
    v_fma_f32 v28, v9, v17, v8
    v_cvt_pk_bf16_f32 v28, v28, v28
    v_lshlrev_b32 v28, 16, v28
    ds_write_b32 v10, v28 offset:4864
    v_add_u32 v19, s56, v14
    v_lshlrev_b32 v19, 2, v19
    v_mov_b32 v32, 0
    v_mov_b32 v33, 0
    v_mov_b32 v34, 0
    v_mov_b32 v35, 0
    v_mov_b32 v36, 0
    v_mov_b32 v37, 0
    v_mov_b32 v38, 0
    v_mov_b32 v39, 0
    s_lshl_b32 s53, s32, 2
    s_add_u32 s53, s53, s50
    s_lshl_b32 s53, s53, 13
    s_add_u32 s53, s53, 524288
    s_add_u32 s42, s30, s53
    s_addc_u32 s43, s31, 0
    s_waitcnt lgkmcnt(0)
    s_cmp_lg_u32 s47, 0
    s_cbranch_scc1 L_c_gu
    ds_read_b32 v64, v19 offset:2816
    ds_read_b32 v65, v19 offset:2848
    ds_read_b32 v66, v19 offset:2880
    ds_read_b32 v67, v19 offset:2912
    ds_read_b32 v68, v19 offset:2944
    ds_read_b32 v69, v19 offset:2976
    ds_read_b32 v70, v19 offset:3008
    ds_read_b32 v71, v19 offset:3040
    ds_read_b32 v72, v19 offset:3072
    ds_read_b32 v73, v19 offset:3104
    ds_read_b32 v74, v19 offset:3136
    ds_read_b32 v75, v19 offset:3168
    s_waitcnt lgkmcnt(0)
    ds_read_b32 v76, v19 offset:3200
    ds_read_b32 v77, v19 offset:3232
    ds_read_b32 v78, v19 offset:3264
    ds_read_b32 v79, v19 offset:3296
    ds_read_b32 v80, v19 offset:3328
    ds_read_b32 v81, v19 offset:3360
    s_waitcnt lgkmcnt(0)
    s_waitcnt vmcnt(17)
    v_lshlrev_b32 v8, 16, v128
    v_and_b32 v9, s39, v128
    v_fmac_f32 v32, v64, v8
    v_fmac_f32 v33, v64, v9
    v_lshlrev_b32 v8, 16, v129
    v_and_b32 v9, s39, v129
    v_fmac_f32 v34, v64, v8
    v_fmac_f32 v35, v64, v9
    v_lshlrev_b32 v8, 16, v130
    v_and_b32 v9, s39, v130
    v_fmac_f32 v36, v64, v8
    v_fmac_f32 v37, v64, v9
    v_lshlrev_b32 v8, 16, v131
    v_and_b32 v9, s39, v131
    v_fmac_f32 v38, v64, v8
    v_fmac_f32 v39, v64, v9
    s_waitcnt vmcnt(16)
    v_lshlrev_b32 v8, 16, v132
    v_and_b32 v9, s39, v132
    v_fmac_f32 v32, v65, v8
    v_fmac_f32 v33, v65, v9
    v_lshlrev_b32 v8, 16, v133
    v_and_b32 v9, s39, v133
    v_fmac_f32 v34, v65, v8
    v_fmac_f32 v35, v65, v9
    v_lshlrev_b32 v8, 16, v134
    v_and_b32 v9, s39, v134
    v_fmac_f32 v36, v65, v8
    v_fmac_f32 v37, v65, v9
    v_lshlrev_b32 v8, 16, v135
    v_and_b32 v9, s39, v135
    v_fmac_f32 v38, v65, v8
    v_fmac_f32 v39, v65, v9
    s_waitcnt vmcnt(15)
    v_lshlrev_b32 v8, 16, v136
    v_and_b32 v9, s39, v136
    v_fmac_f32 v32, v66, v8
    v_fmac_f32 v33, v66, v9
    v_lshlrev_b32 v8, 16, v137
    v_and_b32 v9, s39, v137
    v_fmac_f32 v34, v66, v8
    v_fmac_f32 v35, v66, v9
    v_lshlrev_b32 v8, 16, v138
    v_and_b32 v9, s39, v138
    v_fmac_f32 v36, v66, v8
    v_fmac_f32 v37, v66, v9
    v_lshlrev_b32 v8, 16, v139
    v_and_b32 v9, s39, v139
    v_fmac_f32 v38, v66, v8
    v_fmac_f32 v39, v66, v9
    s_waitcnt vmcnt(14)
    v_lshlrev_b32 v8, 16, v140
    v_and_b32 v9, s39, v140
    v_fmac_f32 v32, v67, v8
    v_fmac_f32 v33, v67, v9
    v_lshlrev_b32 v8, 16, v141
    v_and_b32 v9, s39, v141
    v_fmac_f32 v34, v67, v8
    v_fmac_f32 v35, v67, v9
    v_lshlrev_b32 v8, 16, v142
    v_and_b32 v9, s39, v142
    v_fmac_f32 v36, v67, v8
    v_fmac_f32 v37, v67, v9
    v_lshlrev_b32 v8, 16, v143
    v_and_b32 v9, s39, v143
    v_fmac_f32 v38, v67, v8
    v_fmac_f32 v39, v67, v9
    s_waitcnt vmcnt(13)
    v_lshlrev_b32 v8, 16, v144
    v_and_b32 v9, s39, v144
    v_fmac_f32 v32, v68, v8
    v_fmac_f32 v33, v68, v9
    v_lshlrev_b32 v8, 16, v145
    v_and_b32 v9, s39, v145
    v_fmac_f32 v34, v68, v8
    v_fmac_f32 v35, v68, v9
    v_lshlrev_b32 v8, 16, v146
    v_and_b32 v9, s39, v146
    v_fmac_f32 v36, v68, v8
    v_fmac_f32 v37, v68, v9
    v_lshlrev_b32 v8, 16, v147
    v_and_b32 v9, s39, v147
    v_fmac_f32 v38, v68, v8
    v_fmac_f32 v39, v68, v9
    s_waitcnt vmcnt(12)
    v_lshlrev_b32 v8, 16, v148
    v_and_b32 v9, s39, v148
    v_fmac_f32 v32, v69, v8
    v_fmac_f32 v33, v69, v9
    v_lshlrev_b32 v8, 16, v149
    v_and_b32 v9, s39, v149
    v_fmac_f32 v34, v69, v8
    v_fmac_f32 v35, v69, v9
    v_lshlrev_b32 v8, 16, v150
    v_and_b32 v9, s39, v150
    v_fmac_f32 v36, v69, v8
    v_fmac_f32 v37, v69, v9
    v_lshlrev_b32 v8, 16, v151
    v_and_b32 v9, s39, v151
    v_fmac_f32 v38, v69, v8
    v_fmac_f32 v39, v69, v9
    s_waitcnt vmcnt(11)
    v_lshlrev_b32 v8, 16, v152
    v_and_b32 v9, s39, v152
    v_fmac_f32 v32, v70, v8
    v_fmac_f32 v33, v70, v9
    v_lshlrev_b32 v8, 16, v153
    v_and_b32 v9, s39, v153
    v_fmac_f32 v34, v70, v8
    v_fmac_f32 v35, v70, v9
    v_lshlrev_b32 v8, 16, v154
    v_and_b32 v9, s39, v154
    v_fmac_f32 v36, v70, v8
    v_fmac_f32 v37, v70, v9
    v_lshlrev_b32 v8, 16, v155
    v_and_b32 v9, s39, v155
    v_fmac_f32 v38, v70, v8
    v_fmac_f32 v39, v70, v9
    s_waitcnt vmcnt(10)
    v_lshlrev_b32 v8, 16, v156
    v_and_b32 v9, s39, v156
    v_fmac_f32 v32, v71, v8
    v_fmac_f32 v33, v71, v9
    v_lshlrev_b32 v8, 16, v157
    v_and_b32 v9, s39, v157
    v_fmac_f32 v34, v71, v8
    v_fmac_f32 v35, v71, v9
    v_lshlrev_b32 v8, 16, v158
    v_and_b32 v9, s39, v158
    v_fmac_f32 v36, v71, v8
    v_fmac_f32 v37, v71, v9
    v_lshlrev_b32 v8, 16, v159
    v_and_b32 v9, s39, v159
    v_fmac_f32 v38, v71, v8
    v_fmac_f32 v39, v71, v9
    s_waitcnt vmcnt(9)
    v_lshlrev_b32 v8, 16, v160
    v_and_b32 v9, s39, v160
    v_fmac_f32 v32, v72, v8
    v_fmac_f32 v33, v72, v9
    v_lshlrev_b32 v8, 16, v161
    v_and_b32 v9, s39, v161
    v_fmac_f32 v34, v72, v8
    v_fmac_f32 v35, v72, v9
    v_lshlrev_b32 v8, 16, v162
    v_and_b32 v9, s39, v162
    v_fmac_f32 v36, v72, v8
    v_fmac_f32 v37, v72, v9
    v_lshlrev_b32 v8, 16, v163
    v_and_b32 v9, s39, v163
    v_fmac_f32 v38, v72, v8
    v_fmac_f32 v39, v72, v9
    s_waitcnt vmcnt(8)
    v_lshlrev_b32 v8, 16, v164
    v_and_b32 v9, s39, v164
    v_fmac_f32 v32, v73, v8
    v_fmac_f32 v33, v73, v9
    v_lshlrev_b32 v8, 16, v165
    v_and_b32 v9, s39, v165
    v_fmac_f32 v34, v73, v8
    v_fmac_f32 v35, v73, v9
    v_lshlrev_b32 v8, 16, v166
    v_and_b32 v9, s39, v166
    v_fmac_f32 v36, v73, v8
    v_fmac_f32 v37, v73, v9
    v_lshlrev_b32 v8, 16, v167
    v_and_b32 v9, s39, v167
    v_fmac_f32 v38, v73, v8
    v_fmac_f32 v39, v73, v9
    s_waitcnt vmcnt(7)
    v_lshlrev_b32 v8, 16, v168
    v_and_b32 v9, s39, v168
    v_fmac_f32 v32, v74, v8
    v_fmac_f32 v33, v74, v9
    v_lshlrev_b32 v8, 16, v169
    v_and_b32 v9, s39, v169
    v_fmac_f32 v34, v74, v8
    v_fmac_f32 v35, v74, v9
    v_lshlrev_b32 v8, 16, v170
    v_and_b32 v9, s39, v170
    v_fmac_f32 v36, v74, v8
    v_fmac_f32 v37, v74, v9
    v_lshlrev_b32 v8, 16, v171
    v_and_b32 v9, s39, v171
    v_fmac_f32 v38, v74, v8
    v_fmac_f32 v39, v74, v9
    s_waitcnt vmcnt(6)
    v_lshlrev_b32 v8, 16, v172
    v_and_b32 v9, s39, v172
    v_fmac_f32 v32, v75, v8
    v_fmac_f32 v33, v75, v9
    v_lshlrev_b32 v8, 16, v173
    v_and_b32 v9, s39, v173
    v_fmac_f32 v34, v75, v8
    v_fmac_f32 v35, v75, v9
    v_lshlrev_b32 v8, 16, v174
    v_and_b32 v9, s39, v174
    v_fmac_f32 v36, v75, v8
    v_fmac_f32 v37, v75, v9
    v_lshlrev_b32 v8, 16, v175
    v_and_b32 v9, s39, v175
    v_fmac_f32 v38, v75, v8
    v_fmac_f32 v39, v75, v9
    s_waitcnt vmcnt(5)
    v_lshlrev_b32 v8, 16, v176
    v_and_b32 v9, s39, v176
    v_fmac_f32 v32, v76, v8
    v_fmac_f32 v33, v76, v9
    v_lshlrev_b32 v8, 16, v177
    v_and_b32 v9, s39, v177
    v_fmac_f32 v34, v76, v8
    v_fmac_f32 v35, v76, v9
    v_lshlrev_b32 v8, 16, v178
    v_and_b32 v9, s39, v178
    v_fmac_f32 v36, v76, v8
    v_fmac_f32 v37, v76, v9
    v_lshlrev_b32 v8, 16, v179
    v_and_b32 v9, s39, v179
    v_fmac_f32 v38, v76, v8
    v_fmac_f32 v39, v76, v9
    s_waitcnt vmcnt(4)
    v_lshlrev_b32 v8, 16, v180
    v_and_b32 v9, s39, v180
    v_fmac_f32 v32, v77, v8
    v_fmac_f32 v33, v77, v9
    v_lshlrev_b32 v8, 16, v181
    v_and_b32 v9, s39, v181
    v_fmac_f32 v34, v77, v8
    v_fmac_f32 v35, v77, v9
    v_lshlrev_b32 v8, 16, v182
    v_and_b32 v9, s39, v182
    v_fmac_f32 v36, v77, v8
    v_fmac_f32 v37, v77, v9
    v_lshlrev_b32 v8, 16, v183
    v_and_b32 v9, s39, v183
    v_fmac_f32 v38, v77, v8
    v_fmac_f32 v39, v77, v9
    s_waitcnt vmcnt(3)
    v_lshlrev_b32 v8, 16, v184
    v_and_b32 v9, s39, v184
    v_fmac_f32 v32, v78, v8
    v_fmac_f32 v33, v78, v9
    v_lshlrev_b32 v8, 16, v185
    v_and_b32 v9, s39, v185
    v_fmac_f32 v34, v78, v8
    v_fmac_f32 v35, v78, v9
    v_lshlrev_b32 v8, 16, v186
    v_and_b32 v9, s39, v186
    v_fmac_f32 v36, v78, v8
    v_fmac_f32 v37, v78, v9
    v_lshlrev_b32 v8, 16, v187
    v_and_b32 v9, s39, v187
    v_fmac_f32 v38, v78, v8
    v_fmac_f32 v39, v78, v9
    s_waitcnt vmcnt(2)
    v_lshlrev_b32 v8, 16, v188
    v_and_b32 v9, s39, v188
    v_fmac_f32 v32, v79, v8
    v_fmac_f32 v33, v79, v9
    v_lshlrev_b32 v8, 16, v189
    v_and_b32 v9, s39, v189
    v_fmac_f32 v34, v79, v8
    v_fmac_f32 v35, v79, v9
    v_lshlrev_b32 v8, 16, v190
    v_and_b32 v9, s39, v190
    v_fmac_f32 v36, v79, v8
    v_fmac_f32 v37, v79, v9
    v_lshlrev_b32 v8, 16, v191
    v_and_b32 v9, s39, v191
    v_fmac_f32 v38, v79, v8
    v_fmac_f32 v39, v79, v9
    s_waitcnt vmcnt(1)
    v_lshlrev_b32 v8, 16, v192
    v_and_b32 v9, s39, v192
    v_fmac_f32 v32, v80, v8
    v_fmac_f32 v33, v80, v9
    v_lshlrev_b32 v8, 16, v193
    v_and_b32 v9, s39, v193
    v_fmac_f32 v34, v80, v8
    v_fmac_f32 v35, v80, v9
    v_lshlrev_b32 v8, 16, v194
    v_and_b32 v9, s39, v194
    v_fmac_f32 v36, v80, v8
    v_fmac_f32 v37, v80, v9
    v_lshlrev_b32 v8, 16, v195
    v_and_b32 v9, s39, v195
    v_fmac_f32 v38, v80, v8
    v_fmac_f32 v39, v80, v9
    s_waitcnt vmcnt(0)
    v_lshlrev_b32 v8, 16, v196
    v_and_b32 v9, s39, v196
    v_fmac_f32 v32, v81, v8
    v_fmac_f32 v33, v81, v9
    v_lshlrev_b32 v8, 16, v197
    v_and_b32 v9, s39, v197
    v_fmac_f32 v34, v81, v8
    v_fmac_f32 v35, v81, v9
    v_lshlrev_b32 v8, 16, v198
    v_and_b32 v9, s39, v198
    v_fmac_f32 v36, v81, v8
    v_fmac_f32 v37, v81, v9
    v_lshlrev_b32 v8, 16, v199
    v_and_b32 v9, s39, v199
    v_fmac_f32 v38, v81, v8
    v_fmac_f32 v39, v81, v9
    s_nop 1
    v_add_f32_dpp v32, v32, v32 row_ror:8 row_mask:0xf bank_mask:0xf
    s_nop 1
    v_add_f32_dpp v33, v33, v33 row_ror:8 row_mask:0xf bank_mask:0xf
    s_nop 1
    v_add_f32_dpp v34, v34, v34 row_ror:8 row_mask:0xf bank_mask:0xf
    s_nop 1
    v_add_f32_dpp v35, v35, v35 row_ror:8 row_mask:0xf bank_mask:0xf
    s_nop 1
    v_add_f32_dpp v36, v36, v36 row_ror:8 row_mask:0xf bank_mask:0xf
    s_nop 1
    v_add_f32_dpp v37, v37, v37 row_ror:8 row_mask:0xf bank_mask:0xf
    s_nop 1
    v_add_f32_dpp v38, v38, v38 row_ror:8 row_mask:0xf bank_mask:0xf
    s_nop 1
    v_add_f32_dpp v39, v39, v39 row_ror:8 row_mask:0xf bank_mask:0xf
    v_mov_b32 v8, v32
    s_nop 1
    v_permlane16_swap_b32 v32, v8
    v_add_f32 v32, v32, v8
    v_mov_b32 v8, v32
    s_nop 1
    v_permlane32_swap_b32 v32, v8
    v_add_f32 v32, v32, v8
    v_mov_b32 v8, v33
    s_nop 1
    v_permlane16_swap_b32 v33, v8
    v_add_f32 v33, v33, v8
    v_mov_b32 v8, v33
    s_nop 1
    v_permlane32_swap_b32 v33, v8
    v_add_f32 v33, v33, v8
    v_mov_b32 v8, v34
    s_nop 1
    v_permlane16_swap_b32 v34, v8
    v_add_f32 v34, v34, v8
    v_mov_b32 v8, v34
    s_nop 1
    v_permlane32_swap_b32 v34, v8
    v_add_f32 v34, v34, v8
    v_mov_b32 v8, v35
    s_nop 1
    v_permlane16_swap_b32 v35, v8
    v_add_f32 v35, v35, v8
    v_mov_b32 v8, v35
    s_nop 1
    v_permlane32_swap_b32 v35, v8
    v_add_f32 v35, v35, v8
    v_mov_b32 v8, v36
    s_nop 1
    v_permlane16_swap_b32 v36, v8
    v_add_f32 v36, v36, v8
    v_mov_b32 v8, v36
    s_nop 1
    v_permlane32_swap_b32 v36, v8
    v_add_f32 v36, v36, v8
    v_mov_b32 v8, v37
    s_nop 1
    v_permlane16_swap_b32 v37, v8
    v_add_f32 v37, v37, v8
    v_mov_b32 v8, v37
    s_nop 1
    v_permlane32_swap_b32 v37, v8
    v_add_f32 v37, v37, v8
    v_mov_b32 v8, v38
    s_nop 1
    v_permlane16_swap_b32 v38, v8
    v_add_f32 v38, v38, v8
    v_mov_b32 v8, v38
    s_nop 1
    v_permlane32_swap_b32 v38, v8
    v_add_f32 v38, v38, v8
    v_mov_b32 v8, v39
    s_nop 1
    v_permlane16_swap_b32 v39, v8
    v_add_f32 v39, v39, v8
    v_mov_b32 v8, v39
    s_nop 1
    v_permlane32_swap_b32 v39, v8
    v_add_f32 v39, v39, v8
    s_mov_b32 s45, 3200000
L_lw_12:
    ds_read_b32 v8, v7 offset:12
    s_waitcnt lgkmcnt(0)
    v_readfirstlane_b32 s52, v8
    s_cmp_lg_u32 s52, 0
    s_cbranch_scc1 L_lwd_13
    s_sleep 1
    s_sub_u32 s45, s45, 1
    s_cmp_lg_u32 s45, 0
    s_cbranch_scc1 L_lw_12
L_lwd_13:
    ds_read_b32 v8, v7 offset:24
    s_waitcnt lgkmcnt(0)
    v_readfirstlane_b32 s46, v8
    s_nop 1
    v_mov_b32 v40, v32
    v_mov_b32 v41, s46
    v_mov_b32 v42, v33
    v_mov_b32 v43, s46
    v_mov_b32 v44, v34
    v_mov_b32 v45, s46
    v_mov_b32 v46, v35
    v_mov_b32 v47, s46
    v_mov_b32 v48, v36
    v_mov_b32 v49, s46
    v_mov_b32 v50, v37
    v_mov_b32 v51, s46
    v_mov_b32 v52, v38
    v_mov_b32 v53, s46
    v_mov_b32 v54, v39
    v_mov_b32 v55, s46
    s_lshl_b32 s53, s51, 9
    v_lshlrev_b32 v8, 6, v15
    v_add_u32 v8, s53, v8
    s_mov_b64 exec, 0xff
    global_store_dwordx4 v8, v[40:43], s[42:43] offset:0 sc1
    global_store_dwordx4 v8, v[44:47], s[42:43] offset:16 sc1
    global_store_dwordx4 v8, v[48:51], s[42:43] offset:32 sc1
    global_store_dwordx4 v8, v[52:55], s[42:43] offset:48 sc1
    s_mov_b64 exec, -1
    s_lshl_b32 s53, s32, 15
    s_add_u32 s53, s53, 524288
    s_add_u32 s40, s30, s53
    s_addc_u32 s41, s31, 0
    v_lshlrev_b32 v16, 5, v1
    v_add_u32 v65, 8192, v16
    v_add_u32 v66, 16384, v16
    v_add_u32 v67, 24576, v16
    v_mov_b32 v64, v16
    v_lshrrev_b32 v10, 2, v3
    v_lshlrev_b32 v10, 13, v10
    v_and_b32 v11, 3, v3
    v_lshl_add_u32 v10, v11, 9, v10
    s_sleep 80
    s_mov_b32 s45, 400000
    s_mov_b64 exec, 0xffff
L_lp_14:
    global_load_dwordx2 v[128:129], v10, s[40:41] offset:0 sc1
    s_waitcnt vmcnt(0)
    v_cmp_ne_u32 vcc, s46, v129
    s_cbranch_vccz L_lp_14_d
    s_sleep 40
    s_sub_u32 s45, s45, 1
    s_cmp_lg_u32 s45, 0
    s_cbranch_scc1 L_lp_14
L_lp_14_d:
    s_mov_b64 exec, -1
    s_mov_b32 s45, 400000
L_qpoll:
    global_load_dwordx4 v[128:131], v64, s[40:41] sc1
    global_load_dwordx4 v[132:135], v64, s[40:41] offset:16 sc1
    global_load_dwordx4 v[136:139], v65, s[40:41] sc1
    global_load_dwordx4 v[140:143], v65, s[40:41] offset:16 sc1
    global_load_dwordx4 v[144:147], v66, s[40:41] sc1
    global_load_dwordx4 v[148:151], v66, s[40:41] offset:16 sc1
    global_load_dwordx4 v[152:155], v67, s[40:41] sc1
    global_load_dwordx4 v[156:159], v67, s[40:41] offset:16 sc1
    s_waitcnt vmcnt(0)
    v_max3_u32 v8, v129, v131, v159
    v_min3_u32 v9, v129, v131, v159
    v_max3_u32 v8, v8, v133, v135
    v_min3_u32 v9, v9, v133, v135
    v_max3_u32 v8, v8, v137, v139
    v_min3_u32 v9, v9, v137, v139
    v_max3_u32 v8, v8, v141, v143
    v_min3_u32 v9, v9, v141, v143
    v_max3_u32 v8, v8, v145, v147
    v_min3_u32 v9, v9, v145, v147
    v_max3_u32 v8, v8, v149, v151
    v_min3_u32 v9, v9, v149, v151
    v_max3_u32 v8, v8, v153, v155
    v_min3_u32 v9, v9, v153, v155
    v_max3_u32 v8, v8, v157, v159
    v_min3_u32 v9, v9, v157, v159
    v_xor_b32 v8, s46, v8
    v_xor_b32 v9, s46, v9
    v_or_b32 v8, v8, v9
    v_cmp_ne_u32 vcc, 0, v8
    s_cbranch_vccz L_qpoll_done
    s_sleep 2
    s_sub_u32 s45, s45, 1
    s_cmp_lg_u32 s45, 0
    s_cbranch_scc1 L_qpoll
L_qpoll_done:
    v_add_f32 v128, v128, v136
    v_add_f32 v130, v130, v138
    v_add_f32 v132, v132, v140
    v_add_f32 v134, v134, v142
    v_add_f32 v128, v128, v144
    v_add_f32 v130, v130, v146
    v_add_f32 v132, v132, v148
    v_add_f32 v134, v134, v150
    v_add_f32 v128, v128, v152
    v_add_f32 v130, v130, v154
    v_add_f32 v132, v132, v156
    v_add_f32 v134, v134, v158
    v_cvt_pk_bf16_f32 v128, v128, v130
    v_cvt_pk_bf16_f32 v129, v132, v134
    v_lshlrev_b32 v8, 3, v1
    ds_write_b64 v8, v[128:129] offset:256
    s_mov_b64 exec, 1
    v_mov_b32 v8, 1
    s_waitcnt lgkmcnt(0)
    ds_add_u32 v7, v8 offset:0
    s_mov_b64 exec, -1
    s_cmp_lg_u32 s33, 0
    s_cbranch_scc1 L_end
    s_lshr_b32 s52, s32, 1
    s_and_b32 s53, s32, 1
    s_mul_i32 s54, s52, 36864
    s_mul_i32 s55, s53, 288
    s_add_u32 s54, s54, s55
    s_add_u32 s54, s54, 2097152
    s_add_u32 s40, s30, s54
    s_addc_u32 s41, s31, 0
    v_min_u32 v9, 8, v3
    v_mul_u32_u24 v96, 1152, v4
    v_lshl_add_u32 v96, v9, 5, v96
    v_add_u32 v97, 4608, v96
    v_add_u32 v98, 9216, v96
    v_add_u32 v99, 13824, v96
    v_add_u32 v100, 18432, v96
    v_add_u32 v101, 23040, v96
    v_add_u32 v102, 27648, v96
    v_add_u32 v103, 32256, v96
    s_mul_i32 s56, s32, 72
    v_lshlrev_b32 v104, 3, v9
    v_add_u32 v104, s56, v104
    global_load_dwordx2 v[106:107], v104, s[8:9]
    s_mov_b32 s45, 3200000
L_lw_15:
    ds_read_b32 v8, v7 offset:36
    s_waitcnt lgkmcnt(0)
    v_readfirstlane_b32 s52, v8
    s_cmp_lg_u32 s52, 0
    s_cbranch_scc1 L_lwd_16
    s_sleep 1
    s_sub_u32 s45, s45, 1
    s_cmp_lg_u32 s45, 0
    s_cbranch_scc1 L_lw_15
L_lwd_16:
    v_mul_u32_u24 v10, 1152, v6
    s_mov_b32 s45, 400000
    s_mov_b32 exec_hi, 0
L_lp_17:
    global_load_dwordx2 v[128:129], v10, s[40:41] offset:576 sc1
    s_waitcnt vmcnt(0)
    v_cmp_ne_u32 vcc, s46, v129
    s_cbranch_vccz L_lp_17_d
    s_sleep 16
    s_sub_u32 s45, s45, 1
    s_cmp_lg_u32 s45, 0
    s_cbranch_scc1 L_lp_17
L_lp_17_d:
    s_mov_b64 exec, -1
    s_mov_b32 s45, 400000
L_fpoll1:
    global_load_dwordx4 v[128:131], v96, s[40:41] offset:576 sc1
    global_load_dwordx4 v[132:135], v96, s[40:41] offset:592 sc1
    global_load_dwordx4 v[136:139], v97, s[40:41] offset:576 sc1
    global_load_dwordx4 v[140:143], v97, s[40:41] offset:592 sc1
    global_load_dwordx4 v[144:147], v98, s[40:41] offset:576 sc1
    global_load_dwordx4 v[148:151], v98, s[40:41] offset:592 sc1
    global_load_dwordx4 v[152:155], v99, s[40:41] offset:576 sc1
    global_load_dwordx4 v[156:159], v99, s[40:41] offset:592 sc1
    global_load_dwordx4 v[160:163], v100, s[40:41] offset:576 sc1
    global_load_dwordx4 v[164:167], v100, s[40:41] offset:592 sc1
    global_load_dwordx4 v[168:171], v101, s[40:41] offset:576 sc1
    global_load_dwordx4 v[172:175], v101, s[40:41] offset:592 sc1
    global_load_dwordx4 v[176:179], v102, s[40:41] offset:576 sc1
    global_load_dwordx4 v[180:183], v102, s[40:41] offset:592 sc1
    global_load_dwordx4 v[184:187], v103, s[40:41] offset:576 sc1
    global_load_dwordx4 v[188:191], v103, s[40:41] offset:592 sc1
    s_waitcnt vmcnt(0)
    v_max3_u32 v8, v129, v131, v191
    v_min3_u32 v9, v129, v131, v191
    v_max3_u32 v8, v8, v133, v135
    v_min3_u32 v9, v9, v133, v135
    v_max3_u32 v8, v8, v137, v139
    v_min3_u32 v9, v9, v137, v139
    v_max3_u32 v8, v8, v141, v143
    v_min3_u32 v9, v9, v141, v143
    v_max3_u32 v8, v8, v145, v147
    v_min3_u32 v9, v9, v145, v147
    v_max3_u32 v8, v8, v149, v151
    v_min3_u32 v9, v9, v149, v151
    v_max3_u32 v8, v8, v153, v155
    v_min3_u32 v9, v9, v153, v155
    v_max3_u32 v8, v8, v157, v159
    v_min3_u32 v9, v9, v157, v159
    v_max3_u32 v8, v8, v161, v163
    v_min3_u32 v9, v9, v161, v163
    v_max3_u32 v8, v8, v165, v167
    v_min3_u32 v9, v9, v165, v167
    v_max3_u32 v8, v8, v169, v171
    v_min3_u32 v9, v9, v169, v171
    v_max3_u32 v8, v8, v173, v175
    v_min3_u32 v9, v9, v173, v175
    v_max3_u32 v8, v8, v177, v179
    v_min3_u32 v9, v9, v177, v179
    v_max3_u32 v8, v8, v181, v183
    v_min3_u32 v9, v9, v181, v183
    v_max3_u32 v8, v8, v185, v187
    v_min3_u32 v9, v9, v185, v187
    v_max3_u32 v8, v8, v189, v191
    v_min3_u32 v9, v9, v189, v191
    v_xor_b32 v8, s46, v8
    v_xor_b32 v9, s46, v9
    v_or_b32 v8, v8, v9
    v_cmp_ne_u32 vcc, 0, v8
    s_cbranch_vccz L_fpoll1_d
    s_sleep 16
    s_sub_u32 s45, s45, 1
    s_cmp_lg_u32 s45, 0
    s_cbranch_scc1 L_fpoll1
L_fpoll1_d:
    v_add_f32 v36, v128, v136
    v_add_f32 v36, v36, v144
    v_add_f32 v36, v36, v152
    v_add_f32 v36, v36, v160
    v_add_f32 v36, v36, v168
    v_add_f32 v36, v36, v176
    v_add_f32 v36, v36, v184
    v_add_f32 v37, v130, v138
    v_add_f32 v37, v37, v146
    v_add_f32 v37, v37, v154
    v_add_f32 v37, v37, v162
    v_add_f32 v37, v37, v170
    v_add_f32 v37, v37, v178
    v_add_f32 v37, v37, v186
    v_add_f32 v38, v132, v140
    v_add_f32 v38, v38, v148
    v_add_f32 v38, v38, v156
    v_add_f32 v38, v38, v164
    v_add_f32 v38, v38, v172
    v_add_f32 v38, v38, v180
    v_add_f32 v38, v38, v188
    v_add_f32 v39, v134, v142
    v_add_f32 v39, v39, v150
    v_add_f32 v39, v39, v158
    v_add_f32 v39, v39, v166
    v_add_f32 v39, v39, v174
    v_add_f32 v39, v39, v182
    v_add_f32 v39, v39, v190
    v_mov_b32 v8, v36
    s_nop 1
    v_permlane16_swap_b32 v36, v8
    v_add_f32 v36, v36, v8
    v_mov_b32 v8, v36
    s_nop 1
    v_permlane32_swap_b32 v36, v8
    v_add_f32 v36, v36, v8
    v_mov_b32 v8, v37
    s_nop 1
    v_permlane16_swap_b32 v37, v8
    v_add_f32 v37, v37, v8
    v_mov_b32 v8, v37
    s_nop 1
    v_permlane32_swap_b32 v37, v8
    v_add_f32 v37, v37, v8
    v_mov_b32 v8, v38
    s_nop 1
    v_permlane16_swap_b32 v38, v8
    v_add_f32 v38, v38, v8
    v_mov_b32 v8, v38
    s_nop 1
    v_permlane32_swap_b32 v38, v8
    v_add_f32 v38, v38, v8
    v_mov_b32 v8, v39
    s_nop 1
    v_permlane16_swap_b32 v39, v8
    v_add_f32 v39, v39, v8
    v_mov_b32 v8, v39
    s_nop 1
    v_permlane32_swap_b32 v39, v8
    v_add_f32 v39, v39, v8
    s_mov_b32 s45, 3200000
L_lw_18:
    ds_read_b32 v8, v7 offset:32
    s_waitcnt lgkmcnt(0)
    v_readfirstlane_b32 s52, v8
    s_cmp_lg_u32 s52, 0
    s_cbranch_scc1 L_lwd_19
    s_sleep 1
    s_sub_u32 s45, s45, 1
    s_cmp_lg_u32 s45, 0
    s_cbranch_scc1 L_lw_18
L_lwd_19:
    s_mov_b32 s45, 400000
L_fpoll0:
    global_load_dwordx4 v[128:131], v96, s[40:41] offset:0 sc1
    global_load_dwordx4 v[132:135], v96, s[40:41] offset:16 sc1
    global_load_dwordx4 v[136:139], v97, s[40:41] offset:0 sc1
    global_load_dwordx4 v[140:143], v97, s[40:41] offset:16 sc1
    global_load_dwordx4 v[144:147], v98, s[40:41] offset:0 sc1
    global_load_dwordx4 v[148:151], v98, s[40:41] offset:16 sc1
    global_load_dwordx4 v[152:155], v99, s[40:41] offset:0 sc1
    global_load_dwordx4 v[156:159], v99, s[40:41] offset:16 sc1
    global_load_dwordx4 v[160:163], v100, s[40:41] offset:0 sc1
    global_load_dwordx4 v[164:167], v100, s[40:41] offset:16 sc1
    global_load_dwordx4 v[168:171], v101, s[40:41] offset:0 sc1
    global_load_dwordx4 v[172:175], v101, s[40:41] offset:16 sc1
    global_load_dwordx4 v[176:179], v102, s[40:41] offset:0 sc1
    global_load_dwordx4 v[180:183], v102, s[40:41] offset:16 sc1
    global_load_dwordx4 v[184:187], v103, s[40:41] offset:0 sc1
    global_load_dwordx4 v[188:191], v103, s[40:41] offset:16 sc1
    s_waitcnt vmcnt(0)
    v_max3_u32 v8, v129, v131, v191
    v_min3_u32 v9, v129, v131, v191
    v_max3_u32 v8, v8, v133, v135
    v_min3_u32 v9, v9, v133, v135
    v_max3_u32 v8, v8, v137, v139
    v_min3_u32 v9, v9, v137, v139
    v_max3_u32 v8, v8, v141, v143
    v_min3_u32 v9, v9, v141, v143
    v_max3_u32 v8, v8, v145, v147
    v_min3_u32 v9, v9, v145, v147
    v_max3_u32 v8, v8, v149, v151
    v_min3_u32 v9, v9, v149, v151
    v_max3_u32 v8, v8, v153, v155
    v_min3_u32 v9, v9, v153, v155
    v_max3_u32 v8, v8, v157, v159
    v_min3_u32 v9, v9, v157, v159
    v_max3_u32 v8, v8, v161, v163
    v_min3_u32 v9, v9, v161, v163
    v_max3_u32 v8, v8, v165, v167
    v_min3_u32 v9, v9, v165, v167
    v_max3_u32 v8, v8, v169, v171
    v_min3_u32 v9, v9, v169, v171
    v_max3_u32 v8, v8, v173, v175
    v_min3_u32 v9, v9, v173, v175
    v_max3_u32 v8, v8, v177, v179
    v_min3_u32 v9, v9, v177, v179
    v_max3_u32 v8, v8, v181, v183
    v_min3_u32 v9, v9, v181, v183
    v_max3_u32 v8, v8, v185, v187
    v_min3_u32 v9, v9, v185, v187
    v_max3_u32 v8, v8, v189, v191
    v_min3_u32 v9, v9, v189, v191
    v_xor_b32 v8, s46, v8
    v_xor_b32 v9, s46, v9
    v_or_b32 v8, v8, v9
    v_cmp_ne_u32 vcc, 0, v8
    s_cbranch_vccz L_fpoll0_d
    s_sleep 2
    s_sub_u32 s45, s45, 1
    s_cmp_lg_u32 s45, 0
    s_cbranch_scc1 L_fpoll0
L_fpoll0_d:
    v_add_f32 v32, v128, v136
    v_add_f32 v32, v32, v144
    v_add_f32 v32, v32, v152
    v_add_f32 v32, v32, v160
    v_add_f32 v32, v32, v168
    v_add_f32 v32, v32, v176
    v_add_f32 v32, v32, v184
    v_add_f32 v33, v130, v138
    v_add_f32 v33, v33, v146
    v_add_f32 v33, v33, v154
    v_add_f32 v33, v33, v162
    v_add_f32 v33, v33, v170
    v_add_f32 v33, v33, v178
    v_add_f32 v33, v33, v186
    v_add_f32 v34, v132, v140
    v_add_f32 v34, v34, v148
    v_add_f32 v34, v34, v156
    v_add_f32 v34, v34, v164
    v_add_f32 v34, v34, v172
    v_add_f32 v34, v34, v180
    v_add_f32 v34, v34, v188
    v_add_f32 v35, v134, v142
    v_add_f32 v35, v35, v150
    v_add_f32 v35, v35, v158
    v_add_f32 v35, v35, v166
    v_add_f32 v35, v35, v174
    v_add_f32 v35, v35, v182
    v_add_f32 v35, v35, v190
    v_mov_b32 v8, v32
    s_nop 1
    v_permlane16_swap_b32 v32, v8
    v_add_f32 v32, v32, v8
    v_mov_b32 v8, v32
    s_nop 1
    v_permlane32_swap_b32 v32, v8
    v_add_f32 v32, v32, v8
    v_mov_b32 v8, v33
    s_nop 1
    v_permlane16_swap_b32 v33, v8
    v_add_f32 v33, v33, v8
    v_mov_b32 v8, v33
    s_nop 1
    v_permlane32_swap_b32 v33, v8
    v_add_f32 v33, v33, v8
    v_mov_b32 v8, v34
    s_nop 1
    v_permlane16_swap_b32 v34, v8
    v_add_f32 v34, v34, v8
    v_mov_b32 v8, v34
    s_nop 1
    v_permlane32_swap_b32 v34, v8
    v_add_f32 v34, v34, v8
    v_mov_b32 v8, v35
    s_nop 1
    v_permlane16_swap_b32 v35, v8
    v_add_f32 v35, v35, v8
    v_mov_b32 v8, v35
    s_nop 1
    v_permlane32_swap_b32 v35, v8
    v_add_f32 v35, v35, v8
    v_cvt_pk_bf16_f32 v8, v32, v33
    v_lshlrev_b32 v32, 16, v8
    v_and_b32 v33, s39, v8
    v_cvt_pk_bf16_f32 v8, v34, v35
    v_lshlrev_b32 v34, 16, v8
    v_and_b32 v35, s39, v8
    v_cvt_pk_bf16_f32 v8, v36, v37
    v_lshlrev_b32 v36, 16, v8
    v_and_b32 v37, s39, v8
    v_cvt_pk_bf16_f32 v8, v38, v39
    v_lshlrev_b32 v38, 16, v8
    v_and_b32 v39, s39, v8
    v_lshlrev_b32 v136, 16, v106
    v_and_b32 v137, s39, v106
    v_lshlrev_b32 v138, 16, v107
    v_and_b32 v139, s39, v107
    v_add_f32 v32, v32, v136
    v_add_f32 v33, v33, v137
    v_add_f32 v34, v34, v138
    v_add_f32 v35, v35, v139
    v_cvt_pk_bf16_f32 v8, v32, v33
    v_lshlrev_b32 v32, 16, v8
    v_and_b32 v33, s39, v8
    v_cvt_pk_bf16_f32 v8, v34, v35
    v_lshlrev_b32 v34, 16, v8
    v_and_b32 v35, s39, v8
    v_add_f32 v32, v32, v36
    v_add_f32 v33, v33, v37
    v_add_f32 v34, v34, v38
    v_add_f32 v35, v35, v39
    v_cvt_pk_bf16_f32 v136, v32, v33
    v_cvt_pk_bf16_f32 v137, v34, v35
    s_mov_b64 exec, 0x1ff
    global_store_dwordx2 v104, v[136:137], s[26:27]
    s_cmp_lg_u32 s32, 0
    s_cbranch_scc1 L_noepoch
    s_mov_b64 exec, 1
    v_mov_b32 v8, s46
    global_store_dword v7, v8, s[30:31] offset:0 sc1
L_noepoch:
    s_branch L_end
L_c_gu:
    ds_read_b32 v64, v19 offset:2816
    ds_read_b32 v65, v19 offset:2844
    ds_read_b32 v66, v19 offset:2872
    ds_read_b32 v67, v19 offset:2900
    ds_read_b32 v68, v19 offset:2928
    ds_read_b32 v69, v19 offset:2956
    ds_read_b32 v70, v19 offset:2984
    ds_read_b32 v71, v19 offset:3012
    ds_read_b32 v72, v19 offset:3040
    ds_read_b32 v73, v19 offset:3068
    ds_read_b32 v74, v19 offset:3096
    ds_read_b32 v75, v19 offset:3124
    s_waitcnt lgkmcnt(0)
    ds_read_b32 v76, v19 offset:3152
    ds_read_b32 v77, v19 offset:3180
    ds_read_b32 v78, v19 offset:3208
    ds_read_b32 v79, v19 offset:3236
    ds_read_b32 v80, v19 offset:3264
    ds_read_b32 v81, v19 offset:3292
    ds_read_b32 v82, v19 offset:3320
    ds_read_b32 v83, v19 offset:3348
    ds_read_b32 v84, v19 offset:3376
    s_waitcnt lgkmcnt(0)
    v_cmp_lt_u32 vcc, 3, v14
    s_nop 1
    v_cndmask_b32 v84, v84, v7, vcc
    s_waitcnt vmcnt(20)
    v_lshlrev_b32 v8, 16, v128
    v_and_b32 v9, s39, v128
    v_fmac_f32 v32, v64, v8
    v_fmac_f32 v33, v64, v9
    v_lshlrev_b32 v8, 16, v129
    v_and_b32 v9, s39, v129
    v_fmac_f32 v34, v64, v8
    v_fmac_f32 v35, v64, v9
    v_lshlrev_b32 v8, 16, v130
    v_and_b32 v9, s39, v130
    v_fmac_f32 v36, v64, v8
    v_fmac_f32 v37, v64, v9
    v_lshlrev_b32 v8, 16, v131
    v_and_b32 v9, s39, v131
    v_fmac_f32 v38, v64, v8
    v_fmac_f32 v39, v64, v9
    s_waitcnt vmcnt(19)
    v_lshlrev_b32 v8, 16, v132
    v_and_b32 v9, s39, v132
    v_fmac_f32 v32, v65, v8
    v_fmac_f32 v33, v65, v9
    v_lshlrev_b32 v8, 16, v133
    v_and_b32 v9, s39, v133
    v_fmac_f32 v34, v65, v8
    v_fmac_f32 v35, v65, v9
    v_lshlrev_b32 v8, 16, v134
    v_and_b32 v9, s39, v134
    v_fmac_f32 v36, v65, v8
    v_fmac_f32 v37, v65, v9
    v_lshlrev_b32 v8, 16, v135
    v_and_b32 v9, s39, v135
    v_fmac_f32 v38, v65, v8
    v_fmac_f32 v39, v65, v9
    s_waitcnt vmcnt(18)
    v_lshlrev_b32 v8, 16, v136
    v_and_b32 v9, s39, v136
    v_fmac_f32 v32, v66, v8
    v_fmac_f32 v33, v66, v9
    v_lshlrev_b32 v8, 16, v137
    v_and_b32 v9, s39, v137
    v_fmac_f32 v34, v66, v8
    v_fmac_f32 v35, v66, v9
    v_lshlrev_b32 v8, 16, v138
    v_and_b32 v9, s39, v138
    v_fmac_f32 v36, v66, v8
    v_fmac_f32 v37, v66, v9
    v_lshlrev_b32 v8, 16, v139
    v_and_b32 v9, s39, v139
    v_fmac_f32 v38, v66, v8
    v_fmac_f32 v39, v66, v9
    s_waitcnt vmcnt(17)
    v_lshlrev_b32 v8, 16, v140
    v_and_b32 v9, s39, v140
    v_fmac_f32 v32, v67, v8
    v_fmac_f32 v33, v67, v9
    v_lshlrev_b32 v8, 16, v141
    v_and_b32 v9, s39, v141
    v_fmac_f32 v34, v67, v8
    v_fmac_f32 v35, v67, v9
    v_lshlrev_b32 v8, 16, v142
    v_and_b32 v9, s39, v142
    v_fmac_f32 v36, v67, v8
    v_fmac_f32 v37, v67, v9
    v_lshlrev_b32 v8, 16, v143
    v_and_b32 v9, s39, v143
    v_fmac_f32 v38, v67, v8
    v_fmac_f32 v39, v67, v9
    s_waitcnt vmcnt(16)
    v_lshlrev_b32 v8, 16, v144
    v_and_b32 v9, s39, v144
    v_fmac_f32 v32, v68, v8
    v_fmac_f32 v33, v68, v9
    v_lshlrev_b32 v8, 16, v145
    v_and_b32 v9, s39, v145
    v_fmac_f32 v34, v68, v8
    v_fmac_f32 v35, v68, v9
    v_lshlrev_b32 v8, 16, v146
    v_and_b32 v9, s39, v146
    v_fmac_f32 v36, v68, v8
    v_fmac_f32 v37, v68, v9
    v_lshlrev_b32 v8, 16, v147
    v_and_b32 v9, s39, v147
    v_fmac_f32 v38, v68, v8
    v_fmac_f32 v39, v68, v9
    s_waitcnt vmcnt(15)
    v_lshlrev_b32 v8, 16, v148
    v_and_b32 v9, s39, v148
    v_fmac_f32 v32, v69, v8
    v_fmac_f32 v33, v69, v9
    v_lshlrev_b32 v8, 16, v149
    v_and_b32 v9, s39, v149
    v_fmac_f32 v34, v69, v8
    v_fmac_f32 v35, v69, v9
    v_lshlrev_b32 v8, 16, v150
    v_and_b32 v9, s39, v150
    v_fmac_f32 v36, v69, v8
    v_fmac_f32 v37, v69, v9
    v_lshlrev_b32 v8, 16, v151
    v_and_b32 v9, s39, v151
    v_fmac_f32 v38, v69, v8
    v_fmac_f32 v39, v69, v9
    s_waitcnt vmcnt(14)
    v_lshlrev_b32 v8, 16, v152
    v_and_b32 v9, s39, v152
    v_fmac_f32 v32, v70, v8
    v_fmac_f32 v33, v70, v9
    v_lshlrev_b32 v8, 16, v153
    v_and_b32 v9, s39, v153
    v_fmac_f32 v34, v70, v8
    v_fmac_f32 v35, v70, v9
    v_lshlrev_b32 v8, 16, v154
    v_and_b32 v9, s39, v154
    v_fmac_f32 v36, v70, v8
    v_fmac_f32 v37, v70, v9
    v_lshlrev_b32 v8, 16, v155
    v_and_b32 v9, s39, v155
    v_fmac_f32 v38, v70, v8
    v_fmac_f32 v39, v70, v9
    s_waitcnt vmcnt(13)
    v_lshlrev_b32 v8, 16, v156
    v_and_b32 v9, s39, v156
    v_fmac_f32 v32, v71, v8
    v_fmac_f32 v33, v71, v9
    v_lshlrev_b32 v8, 16, v157
    v_and_b32 v9, s39, v157
    v_fmac_f32 v34, v71, v8
    v_fmac_f32 v35, v71, v9
    v_lshlrev_b32 v8, 16, v158
    v_and_b32 v9, s39, v158
    v_fmac_f32 v36, v71, v8
    v_fmac_f32 v37, v71, v9
    v_lshlrev_b32 v8, 16, v159
    v_and_b32 v9, s39, v159
    v_fmac_f32 v38, v71, v8
    v_fmac_f32 v39, v71, v9
    s_waitcnt vmcnt(12)
    v_lshlrev_b32 v8, 16, v160
    v_and_b32 v9, s39, v160
    v_fmac_f32 v32, v72, v8
    v_fmac_f32 v33, v72, v9
    v_lshlrev_b32 v8, 16, v161
    v_and_b32 v9, s39, v161
    v_fmac_f32 v34, v72, v8
    v_fmac_f32 v35, v72, v9
    v_lshlrev_b32 v8, 16, v162
    v_and_b32 v9, s39, v162
    v_fmac_f32 v36, v72, v8
    v_fmac_f32 v37, v72, v9
    v_lshlrev_b32 v8, 16, v163
    v_and_b32 v9, s39, v163
    v_fmac_f32 v38, v72, v8
    v_fmac_f32 v39, v72, v9
    s_waitcnt vmcnt(11)
    v_lshlrev_b32 v8, 16, v164
    v_and_b32 v9, s39, v164
    v_fmac_f32 v32, v73, v8
    v_fmac_f32 v33, v73, v9
    v_lshlrev_b32 v8, 16, v165
    v_and_b32 v9, s39, v165
    v_fmac_f32 v34, v73, v8
    v_fmac_f32 v35, v73, v9
    v_lshlrev_b32 v8, 16, v166
    v_and_b32 v9, s39, v166
    v_fmac_f32 v36, v73, v8
    v_fmac_f32 v37, v73, v9
    v_lshlrev_b32 v8, 16, v167
    v_and_b32 v9, s39, v167
    v_fmac_f32 v38, v73, v8
    v_fmac_f32 v39, v73, v9
    s_waitcnt vmcnt(10)
    v_lshlrev_b32 v8, 16, v168
    v_and_b32 v9, s39, v168
    v_fmac_f32 v32, v74, v8
    v_fmac_f32 v33, v74, v9
    v_lshlrev_b32 v8, 16, v169
    v_and_b32 v9, s39, v169
    v_fmac_f32 v34, v74, v8
    v_fmac_f32 v35, v74, v9
    v_lshlrev_b32 v8, 16, v170
    v_and_b32 v9, s39, v170
    v_fmac_f32 v36, v74, v8
    v_fmac_f32 v37, v74, v9
    v_lshlrev_b32 v8, 16, v171
    v_and_b32 v9, s39, v171
    v_fmac_f32 v38, v74, v8
    v_fmac_f32 v39, v74, v9
    s_waitcnt vmcnt(9)
    v_lshlrev_b32 v8, 16, v172
    v_and_b32 v9, s39, v172
    v_fmac_f32 v32, v75, v8
    v_fmac_f32 v33, v75, v9
    v_lshlrev_b32 v8, 16, v173
    v_and_b32 v9, s39, v173
    v_fmac_f32 v34, v75, v8
    v_fmac_f32 v35, v75, v9
    v_lshlrev_b32 v8, 16, v174
    v_and_b32 v9, s39, v174
    v_fmac_f32 v36, v75, v8
    v_fmac_f32 v37, v75, v9
    v_lshlrev_b32 v8, 16, v175
    v_and_b32 v9, s39, v175
    v_fmac_f32 v38, v75, v8
    v_fmac_f32 v39, v75, v9
    s_waitcnt vmcnt(8)
    v_lshlrev_b32 v8, 16, v176
    v_and_b32 v9, s39, v176
    v_fmac_f32 v32, v76, v8
    v_fmac_f32 v33, v76, v9
    v_lshlrev_b32 v8, 16, v177
    v_and_b32 v9, s39, v177
    v_fmac_f32 v34, v76, v8
    v_fmac_f32 v35, v76, v9
    v_lshlrev_b32 v8, 16, v178
    v_and_b32 v9, s39, v178
    v_fmac_f32 v36, v76, v8
    v_fmac_f32 v37, v76, v9
    v_lshlrev_b32 v8, 16, v179
    v_and_b32 v9, s39, v179
    v_fmac_f32 v38, v76, v8
    v_fmac_f32 v39, v76, v9
    s_waitcnt vmcnt(7)
    v_lshlrev_b32 v8, 16, v180
    v_and_b32 v9, s39, v180
    v_fmac_f32 v32, v77, v8
    v_fmac_f32 v33, v77, v9
    v_lshlrev_b32 v8, 16, v181
    v_and_b32 v9, s39, v181
    v_fmac_f32 v34, v77, v8
    v_fmac_f32 v35, v77, v9
    v_lshlrev_b32 v8, 16, v182
    v_and_b32 v9, s39, v182
    v_fmac_f32 v36, v77, v8
    v_fmac_f32 v37, v77, v9
    v_lshlrev_b32 v8, 16, v183
    v_and_b32 v9, s39, v183
    v_fmac_f32 v38, v77, v8
    v_fmac_f32 v39, v77, v9
    s_waitcnt vmcnt(6)
    v_lshlrev_b32 v8, 16, v184
    v_and_b32 v9, s39, v184
    v_fmac_f32 v32, v78, v8
    v_fmac_f32 v33, v78, v9
    v_lshlrev_b32 v8, 16, v185
    v_and_b32 v9, s39, v185
    v_fmac_f32 v34, v78, v8
    v_fmac_f32 v35, v78, v9
    v_lshlrev_b32 v8, 16, v186
    v_and_b32 v9, s39, v186
    v_fmac_f32 v36, v78, v8
    v_fmac_f32 v37, v78, v9
    v_lshlrev_b32 v8, 16, v187
    v_and_b32 v9, s39, v187
    v_fmac_f32 v38, v78, v8
    v_fmac_f32 v39, v78, v9
    s_waitcnt vmcnt(5)
    v_lshlrev_b32 v8, 16, v188
    v_and_b32 v9, s39, v188
    v_fmac_f32 v32, v79, v8
    v_fmac_f32 v33, v79, v9
    v_lshlrev_b32 v8, 16, v189
    v_and_b32 v9, s39, v189
    v_fmac_f32 v34, v79, v8
    v_fmac_f32 v35, v79, v9
    v_lshlrev_b32 v8, 16, v190
    v_and_b32 v9, s39, v190
    v_fmac_f32 v36, v79, v8
    v_fmac_f32 v37, v79, v9
    v_lshlrev_b32 v8, 16, v191
    v_and_b32 v9, s39, v191
    v_fmac_f32 v38, v79, v8
    v_fmac_f32 v39, v79, v9
    s_waitcnt vmcnt(4)
    v_lshlrev_b32 v8, 16, v192
    v_and_b32 v9, s39, v192
    v_fmac_f32 v32, v80, v8
    v_fmac_f32 v33, v80, v9
    v_lshlrev_b32 v8, 16, v193
    v_and_b32 v9, s39, v193
    v_fmac_f32 v34, v80, v8
    v_fmac_f32 v35, v80, v9
    v_lshlrev_b32 v8, 16, v194
    v_and_b32 v9, s39, v194
    v_fmac_f32 v36, v80, v8
    v_fmac_f32 v37, v80, v9
    v_lshlrev_b32 v8, 16, v195
    v_and_b32 v9, s39, v195
    v_fmac_f32 v38, v80, v8
    v_fmac_f32 v39, v80, v9
    s_waitcnt vmcnt(3)
    v_lshlrev_b32 v8, 16, v196
    v_and_b32 v9, s39, v196
    v_fmac_f32 v32, v81, v8
    v_fmac_f32 v33, v81, v9
    v_lshlrev_b32 v8, 16, v197
    v_and_b32 v9, s39, v197
    v_fmac_f32 v34, v81, v8
    v_fmac_f32 v35, v81, v9
    v_lshlrev_b32 v8, 16, v198
    v_and_b32 v9, s39, v198
    v_fmac_f32 v36, v81, v8
    v_fmac_f32 v37, v81, v9
    v_lshlrev_b32 v8, 16, v199
    v_and_b32 v9, s39, v199
    v_fmac_f32 v38, v81, v8
    v_fmac_f32 v39, v81, v9
    s_waitcnt vmcnt(2)
    v_lshlrev_b32 v8, 16, v200
    v_and_b32 v9, s39, v200
    v_fmac_f32 v32, v82, v8
    v_fmac_f32 v33, v82, v9
    v_lshlrev_b32 v8, 16, v201
    v_and_b32 v9, s39, v201
    v_fmac_f32 v34, v82, v8
    v_fmac_f32 v35, v82, v9
    v_lshlrev_b32 v8, 16, v202
    v_and_b32 v9, s39, v202
    v_fmac_f32 v36, v82, v8
    v_fmac_f32 v37, v82, v9
    v_lshlrev_b32 v8, 16, v203
    v_and_b32 v9, s39, v203
    v_fmac_f32 v38, v82, v8
    v_fmac_f32 v39, v82, v9
    s_waitcnt vmcnt(1)
    v_lshlrev_b32 v8, 16, v204
    v_and_b32 v9, s39, v204
    v_fmac_f32 v32, v83, v8
    v_fmac_f32 v33, v83, v9
    v_lshlrev_b32 v8, 16, v205
    v_and_b32 v9, s39, v205
    v_fmac_f32 v34, v83, v8
    v_fmac_f32 v35, v83, v9
    v_lshlrev_b32 v8, 16, v206
    v_and_b32 v9, s39, v206
    v_fmac_f32 v36, v83, v8
    v_fmac_f32 v37, v83, v9
    v_lshlrev_b32 v8, 16, v207
    v_and_b32 v9, s39, v207
    v_fmac_f32 v38, v83, v8
    v_fmac_f32 v39, v83, v9
    s_waitcnt vmcnt(0)
    v_lshlrev_b32 v8, 16, v208
    v_and_b32 v9, s39, v208
    v_fmac_f32 v32, v84, v8
    v_fmac_f32 v33, v84, v9
    v_lshlrev_b32 v8, 16, v209
    v_and_b32 v9, s39, v209
    v_fmac_f32 v34, v84, v8
    v_fmac_f32 v35, v84, v9
    v_lshlrev_b32 v8, 16, v210
    v_and_b32 v9, s39, v210
    v_fmac_f32 v36, v84, v8
    v_fmac_f32 v37, v84, v9
    v_lshlrev_b32 v8, 16, v211
    v_and_b32 v9, s39, v211
    v_fmac_f32 v38, v84, v8
    v_fmac_f32 v39, v84, v9
    s_sub_u32 s53, s47, 1
    s_lshl_b32 s53, s53, 11
    v_lshlrev_b32 v8, 5, v1
    v_add_u32 v8, s53, v8
    ds_write_b128 v8, v[32:35] offset:12288
    ds_write_b128 v8, v[36:39] offset:12304
    v_min_u32 v15, 8, v1
    v_lshlrev_b32 v8, 5, v15
    v_add_u32 v8, s53, v8
    s_waitcnt lgkmcnt(0)
    ds_read_b128 v[128:131], v8 offset:12288
    ds_read_b128 v[132:135], v8 offset:12304
    ds_read_b128 v[136:139], v8 offset:12576
    ds_read_b128 v[140:143], v8 offset:12592
    ds_read_b128 v[144:147], v8 offset:12864
    ds_read_b128 v[148:151], v8 offset:12880
    ds_read_b128 v[152:155], v8 offset:13152
    ds_read_b128 v[156:159], v8 offset:13168
    ds_read_b128 v[160:163], v8 offset:13440
    ds_read_b128 v[164:167], v8 offset:13456
    ds_read_b128 v[168:171], v8 offset:13728
    ds_read_b128 v[172:175], v8 offset:13744
    ds_read_b128 v[176:179], v8 offset:14016
    ds_read_b128 v[180:183], v8 offset:14032
    s_waitcnt lgkmcnt(0)
    v_add_f32 v128, v128, v136
    v_add_f32 v129, v129, v137
    v_add_f32 v130, v130, v138
    v_add_f32 v131, v131, v139
    v_add_f32 v132, v132, v140
    v_add_f32 v133, v133, v141
    v_add_f32 v134, v134, v142
    v_add_f32 v135, v135, v143
    v_add_f32 v128, v128, v144
    v_add_f32 v129, v129, v145
    v_add_f32 v130, v130, v146
    v_add_f32 v131, v131, v147
    v_add_f32 v132, v132, v148
    v_add_f32 v133, v133, v149
    v_add_f32 v134, v134, v150
    v_add_f32 v135, v135, v151
    v_add_f32 v128, v128, v152
    v_add_f32 v129, v129, v153
    v_add_f32 v130, v130, v154
    v_add_f32 v131, v131, v155
    v_add_f32 v132, v132, v156
    v_add_f32 v133, v133, v157
    v_add_f32 v134, v134, v158
    v_add_f32 v135, v135, v159
    v_add_f32 v128, v128, v160
    v_add_f32 v129, v129, v161
    v_add_f32 v130, v130, v162
    v_add_f32 v131, v131, v163
    v_add_f32 v132, v132, v164
    v_add_f32 v133, v133, v165
    v_add_f32 v134, v134, v166
    v_add_f32 v135, v135, v167
    v_add_f32 v128, v128, v168
    v_add_f32 v129, v129, v169
    v_add_f32 v130, v130, v170
    v_add_f32 v131, v131, v171
    v_add_f32 v132, v132, v172
    v_add_f32 v133, v133, v173
    v_add_f32 v134, v134, v174
    v_add_f32 v135, v135, v175
    v_add_f32 v128, v128, v176
    v_add_f32 v129, v129, v177
    v_add_f32 v130, v130, v178
    v_add_f32 v131, v131, v179
    v_add_f32 v132, v132, v180
    v_add_f32 v133, v133, v181
    v_add_f32 v134, v134, v182
    v_add_f32 v135, v135, v183
    s_mov_b32 s45, 3200000
L_lw_20:
    ds_read_b32 v8, v7 offset:12
    s_waitcnt lgkmcnt(0)
    v_readfirstlane_b32 s52, v8
    s_cmp_lg_u32 s52, 0
    s_cbranch_scc1 L_lwd_21
    s_sleep 1
    s_sub_u32 s45, s45, 1
    s_cmp_lg_u32 s45, 0
    s_cbranch_scc1 L_lw_20
L_lwd_21:
    ds_read_b32 v8, v7 offset:24
    s_waitcnt lgkmcnt(0)
    v_readfirstlane_b32 s46, v8
    s_nop 1
    v_mov_b32 v40, v128
    v_mov_b32 v41, s46
    v_mov_b32 v42, v129
    v_mov_b32 v43, s46
    v_mov_b32 v44, v130
    v_mov_b32 v45, s46
    v_mov_b32 v46, v131
    v_mov_b32 v47, s46
    v_mov_b32 v48, v132
    v_mov_b32 v49, s46
    v_mov_b32 v50, v133
    v_mov_b32 v51, s46
    v_mov_b32 v52, v134
    v_mov_b32 v53, s46
    v_mov_b32 v54, v135
    v_mov_b32 v55, s46
    s_mul_i32 s53, s47, 2304
    s_mul_i32 s54, s51, 576
    s_add_u32 s53, s53, s54
    s_sub_u32 s53, s53, 256
    v_lshlrev_b32 v8, 6, v15
    v_add_u32 v8, s53, v8
    s_mov_b64 exec, 0x1ff
    global_store_dwordx4 v8, v[40:43], s[42:43] offset:0 sc1
    global_store_dwordx4 v8, v[44:47], s[42:43] offset:16 sc1
    global_store_dwordx4 v8, v[48:51], s[42:43] offset:32 sc1
    global_store_dwordx4 v8, v[52:55], s[42:43] offset:48 sc1
    s_mov_b64 exec, -1
    s_cmp_eq_u32 s47, 2
    s_cbranch_scc1 L_x2
    s_lshl_b32 s53, s32, 15
    s_add_u32 s53, s53, 524288
    s_add_u32 s40, s30, s53
    s_addc_u32 s41, s31, 0
    v_min_u32 v15, 35, v1
    s_mul_i32 s53, s35, 1152
    s_add_u32 s53, s53, 2048
    v_lshlrev_b32 v16, 5, v15
    v_add_u32 v64, s53, v16
    v_add_u32 v65, 8192, v64
    v_add_u32 v66, 16384, v64
    v_add_u32 v67, 24576, v64
    v_lshrrev_b32 v10, 2, v3
    v_lshlrev_b32 v10, 13, v10
    v_and_b32 v11, 1, v3
    v_mul_u32_u24 v11, 576, v11
    v_add_u32 v10, v10, v11
    v_bfe_u32 v11, v3, 1, 1
    v_mul_u32_u24 v11, 2304, v11
    v_add_u32 v10, v10, v11
    v_add_u32 v10, s53, v10
    s_sleep 127
    s_mov_b32 s45, 400000
    s_mov_b64 exec, 0xffff
L_lp_22:
    global_load_dwordx2 v[128:129], v10, s[40:41] offset:0 sc1
    s_waitcnt vmcnt(0)
    v_cmp_ne_u32 vcc, s46, v129
    s_cbranch_vccz L_lp_22_d
    s_sleep 80
    s_sub_u32 s45, s45, 1
    s_cmp_lg_u32 s45, 0
    s_cbranch_scc1 L_lp_22
L_lp_22_d:
    s_mov_b64 exec, -1
    s_mov_b32 s45, 400000
L_hpoll:
    global_load_dwordx4 v[128:131], v64, s[40:41] offset:0 sc1
    global_load_dwordx4 v[132:135], v64, s[40:41] offset:16 sc1
    global_load_dwordx4 v[136:139], v64, s[40:41] offset:2304 sc1
    global_load_dwordx4 v[140:143], v64, s[40:41] offset:2320 sc1
    global_load_dwordx4 v[144:147], v65, s[40:41] offset:0 sc1
    global_load_dwordx4 v[148:151], v65, s[40:41] offset:16 sc1
    global_load_dwordx4 v[152:155], v65, s[40:41] offset:2304 sc1
    global_load_dwordx4 v[156:159], v65, s[40:41] offset:2320 sc1
    global_load_dwordx4 v[160:163], v66, s[40:41] offset:0 sc1
    global_load_dwordx4 v[164:167], v66, s[40:41] offset:16 sc1
    global_load_dwordx4 v[168:171], v66, s[40:41] offset:2304 sc1
    global_load_dwordx4 v[172:175], v66, s[40:41] offset:2320 sc1
    global_load_dwordx4 v[176:179], v67, s[40:41] offset:0 sc1
    global_load_dwordx4 v[180:183], v67, s[40:41] offset:16 sc1
    global_load_dwordx4 v[184:187], v67, s[40:41] offset:2304 sc1
    global_load_dwordx4 v[188:191], v67, s[40:41] offset:2320 sc1
    s_waitcnt vmcnt(0)
    v_max3_u32 v8, v129, v131, v191
    v_min3_u32 v9, v129, v131, v191
    v_max3_u32 v8, v8, v133, v135
    v_min3_u32 v9, v9, v133, v135
    v_max3_u32 v8, v8, v137, v139
    v_min3_u32 v9, v9, v137, v139
    v_max3_u32 v8, v8, v141, v143
    v_min3_u32 v9, v9, v141, v143
    v_max3_u32 v8, v8, v145, v147
    v_min3_u32 v9, v9, v145, v147
    v_max3_u32 v8, v8, v149, v151
    v_min3_u32 v9, v9, v149, v151
    v_max3_u32 v8, v8, v153, v155
    v_min3_u32 v9, v9, v153, v155
    v_max3_u32 v8, v8, v157, v159
    v_min3_u32 v9, v9, v157, v159
    v_max3_u32 v8, v8, v161, v163
    v_min3_u32 v9, v9, v161, v163
    v_max3_u32 v8, v8, v165, v167
    v_min3_u32 v9, v9, v165, v167
    v_max3_u32 v8, v8, v169, v171
    v_min3_u32 v9, v9, v169, v171
    v_max3_u32 v8, v8, v173, v175
    v_min3_u32 v9, v9, v173, v175
    v_max3_u32 v8, v8, v177, v179
    v_min3_u32 v9, v9, v177, v179
    v_max3_u32 v8, v8, v181, v183
    v_min3_u32 v9, v9, v181, v183
    v_max3_u32 v8, v8, v185, v187
    v_min3_u32 v9, v9, v185, v187
    v_max3_u32 v8, v8, v189, v191
    v_min3_u32 v9, v9, v189, v191
    v_xor_b32 v8, s46, v8
    v_xor_b32 v9, s46, v9
    v_or_b32 v8, v8, v9
    v_cmp_ne_u32 vcc, 0, v8
    s_cbranch_vccz L_hpoll_done
    s_sleep 8
    s_sub_u32 s45, s45, 1
    s_cmp_lg_u32 s45, 0
    s_cbranch_scc1 L_hpoll
L_hpoll_done:
    v_add_f32 v32, v128, v144
    v_add_f32 v32, v32, v160
    v_add_f32 v32, v32, v176
    v_add_f32 v33, v130, v146
    v_add_f32 v33, v33, v162
    v_add_f32 v33, v33, v178
    v_add_f32 v34, v132, v148
    v_add_f32 v34, v34, v164
    v_add_f32 v34, v34, v180
    v_add_f32 v35, v134, v150
    v_add_f32 v35, v35, v166
    v_add_f32 v35, v35, v182
    v_add_f32 v36, v136, v152
    v_add_f32 v36, v36, v168
    v_add_f32 v36, v36, v184
    v_add_f32 v37, v138, v154
    v_add_f32 v37, v37, v170
    v_add_f32 v37, v37, v186
    v_add_f32 v38, v140, v156
    v_add_f32 v38, v38, v172
    v_add_f32 v38, v38, v188
    v_add_f32 v39, v142, v158
    v_add_f32 v39, v39, v174
    v_add_f32 v39, v39, v190
    v_cvt_pk_bf16_f32 v9, v32, v33
    v_lshlrev_b32 v32, 16, v9
    v_and_b32 v33, s39, v9
    v_cvt_pk_bf16_f32 v9, v34, v35
    v_lshlrev_b32 v34, 16, v9
    v_and_b32 v35, s39, v9
    v_cvt_pk_bf16_f32 v9, v36, v37
    v_lshlrev_b32 v36, 16, v9
    v_and_b32 v37, s39, v9
    v_cvt_pk_bf16_f32 v9, v38, v39
    v_lshlrev_b32 v38, 16, v9
    v_and_b32 v39, s39, v9
    v_mul_f32 v128, s44, v32
    v_exp_f32 v128, -v128
    s_nop 0
    v_add_f32 v128, 1.0, v128
    v_rcp_f32 v128, v128
    s_nop 0
    v_mul_f32 v32, v32, v128
    v_mul_f32 v129, s44, v33
    v_exp_f32 v129, -v129
    s_nop 0
    v_add_f32 v129, 1.0, v129
    v_rcp_f32 v129, v129
    s_nop 0
    v_mul_f32 v33, v33, v129
    v_mul_f32 v130, s44, v34
    v_exp_f32 v130, -v130
    s_nop 0
    v_add_f32 v130, 1.0, v130
    v_rcp_f32 v130, v130
    s_nop 0
    v_mul_f32 v34, v34, v130
    v_mul_f32 v131, s44, v35
    v_exp_f32 v131, -v131
    s_nop 0
    v_add_f32 v131, 1.0, v131
    v_rcp_f32 v131, v131
    s_nop 0
    v_mul_f32 v35, v35, v131
    v_cvt_pk_bf16_f32 v9, v32, v33
    v_lshlrev_b32 v32, 16, v9
    v_and_b32 v33, s39, v9
    v_cvt_pk_bf16_f32 v9, v34, v35
    v_lshlrev_b32 v34, 16, v9
    v_and_b32 v35, s39, v9
    v_mul_f32 v32, v32, v36
    v_mul_f32 v33, v33, v37
    v_mul_f32 v34, v34, v38
    v_mul_f32 v35, v35, v39
    v_cvt_pk_bf16_f32 v136, v32, v33
    v_cvt_pk_bf16_f32 v137, v34, v35
    v_lshlrev_b32 v8, 3, v15
    ds_write_b64 v8, v[136:137] offset:1152
    s_mov_b64 exec, 1
    v_mov_b32 v8, 1
    s_waitcnt lgkmcnt(0)
    ds_add_u32 v7, v8 offset:4
    s_mov_b64 exec, -1
    s_branch L_end
L_x2:
    s_mov_b32 s45, 3200000
L_lw_23:
    ds_read_b32 v8, v7 offset:16
    s_waitcnt lgkmcnt(0)
    v_readfirstlane_b32 s52, v8
    s_cmp_eq_u32 s52, 4
    s_cbranch_scc1 L_lwd_24
    s_sleep 2
    s_sub_u32 s45, s45, 1
    s_cmp_lg_u32 s45, 0
    s_cbranch_scc1 L_lw_23
L_lwd_24:
    v_min_u32 v9, 8, v3
    v_mul_u32_u24 v12, 9216, v4
    v_lshl_add_u32 v12, v9, 4, v12
    v_add_u32 v13, 4608, v12
    s_lshl_b32 s52, s32, 1
    s_add_u32 s52, s52, s35
    s_mul_i32 s53, s52, 147456
    s_mul_i32 s54, s36, 144
    s_add_u32 s53, s53, s54
    s_add_u32 s40, s16, s53
    s_addc_u32 s41, s17, 0
    global_load_dwordx4 v[128:131], v12, s[40:41] offset:0 nt
    global_load_dwordx4 v[132:135], v12, s[40:41] offset:1152 nt
    global_load_dwordx4 v[136:139], v12, s[40:41] offset:2304 nt
    global_load_dwordx4 v[140:143], v12, s[40:41] offset:3456 nt
    global_load_dwordx4 v[144:147], v13, s[40:41] offset:0 nt
    global_load_dwordx4 v[148:151], v13, s[40:41] offset:1152 nt
    global_load_dwordx4 v[152:155], v13, s[40:41] offset:2304 nt
    global_load_dwordx4 v[156:159], v13, s[40:41] offset:3456 nt
    s_add_u32 s40, s40, 36864
    s_addc_u32 s41, s41, 0
    global_load_dwordx4 v[160:163], v12, s[40:41] offset:0 nt
    global_load_dwordx4 v[164:167], v12, s[40:41] offset:1152 nt
    global_load_dwordx4 v[168:171], v12, s[40:41] offset:2304 nt
    global_load_dwordx4 v[172:175], v12, s[40:41] offset:3456 nt
    global_load_dwordx4 v[176:179], v13, s[40:41] offset:0 nt
    global_load_dwordx4 v[180:183], v13, s[40:41] offset:1152 nt
    global_load_dwordx4 v[184:187], v13, s[40:41] offset:2304 nt
    global_load_dwordx4 v[188:191], v13, s[40:41] offset:3456 nt
    s_add_u32 s40, s40, 36864
    s_addc_u32 s41, s41, 0
    global_load_dwordx4 v[192:195], v12, s[40:41] offset:0 nt
    global_load_dwordx4 v[196:199], v12, s[40:41] offset:1152 nt
    global_load_dwordx4 v[200:203], v12, s[40:41] offset:2304 nt
    global_load_dwordx4 v[204:207], v12, s[40:41] offset:3456 nt
    global_load_dwordx4 v[208:211], v13, s[40:41] offset:0 nt
    global_load_dwordx4 v[212:215], v13, s[40:41] offset:1152 nt
    global_load_dwordx4 v[216:219], v13, s[40:41] offset:2304 nt
    global_load_dwordx4 v[220:223], v13, s[40:41] offset:3456 nt
    s_add_u32 s40, s40, 36864
    s_addc_u32 s41, s41, 0
    global_load_dwordx4 v[224:227], v12, s[40:41] offset:0 nt
    global_load_dwordx4 v[228:231], v12, s[40:41] offset:1152 nt
    global_load_dwordx4 v[232:235], v12, s[40:41] offset:2304 nt
    global_load_dwordx4 v[236:239], v12, s[40:41] offset:3456 nt
    global_load_dwordx4 v[240:243], v13, s[40:41] offset:0 nt
    global_load_dwordx4 v[244:247], v13, s[40:41] offset:1152 nt
    global_load_dwordx4 v[248:251], v13, s[40:41] offset:2304 nt
    global_load_dwordx4 v[252:255], v13, s[40:41] offset:3456 nt
    s_mul_i32 s53, s52, 20480
    s_add_u32 s53, s53, 1048576
    s_add_u32 s42, s30, s53
    s_addc_u32 s43, s31, 0
    s_lshl_b32 s53, s36, 5
    s_lshl_b32 s54, s32, 1
    s_add_u32 s53, s53, s54
    s_add_u32 s53, s53, s35
    s_mul_i32 s53, s53, 1152
    s_add_u32 s53, s53, 2097152
    s_add_u32 s48, s30, s53
    s_addc_u32 s49, s31, 0
    v_lshlrev_b32 v14, 4, v1
    v_add_u32 v15, 3840, v14
    v_add_u32 v16, 7680, v14
    v_add_u32 v17, 11520, v14
    v_add_u32 v18, 15360, v14
    v_add_u32 v19, 19200, v14
    v_mul_u32_u24 v20, 1280, v3
    s_waitcnt vmcnt(24)
    v_perm_b32 v96, v132, v128, s37
    v_perm_b32 v97, v140, v136, s37
    v_perm_b32 v98, v148, v144, s37
    v_perm_b32 v99, v156, v152, s37
    v_perm_b32 v100, v132, v128, s38
    v_perm_b32 v101, v140, v136, s38
    v_perm_b32 v102, v148, v144, s38
    v_perm_b32 v103, v156, v152, s38
    v_perm_b32 v104, v133, v129, s37
    v_perm_b32 v105, v141, v137, s37
    v_perm_b32 v106, v149, v145, s37
    v_perm_b32 v107, v157, v153, s37
    v_perm_b32 v108, v133, v129, s38
    v_perm_b32 v109, v141, v137, s38
    v_perm_b32 v110, v149, v145, s38
    v_perm_b32 v111, v157, v153, s38
    v_perm_b32 v112, v134, v130, s37
    v_perm_b32 v113, v142, v138, s37
    v_perm_b32 v114, v150, v146, s37
    v_perm_b32 v115, v158, v154, s37
    v_perm_b32 v116, v134, v130, s38
    v_perm_b32 v117, v142, v138, s38
    v_perm_b32 v118, v150, v146, s38
    v_perm_b32 v119, v158, v154, s38
    v_perm_b32 v120, v135, v131, s37
    v_perm_b32 v121, v143, v139, s37
    v_perm_b32 v122, v151, v147, s37
    v_perm_b32 v123, v159, v155, s37
    v_perm_b32 v124, v135, v131, s38
    v_perm_b32 v125, v143, v139, s38
    v_perm_b32 v126, v151, v147, s38
    v_perm_b32 v127, v159, v155, s38
    s_waitcnt vmcnt(16)
    v_perm_b32 v128, v164, v160, s37
    v_perm_b32 v129, v172, v168, s37
    v_perm_b32 v130, v180, v176, s37
    v_perm_b32 v131, v188, v184, s37
    v_perm_b32 v132, v164, v160, s38
    v_perm_b32 v133, v172, v168, s38
    v_perm_b32 v134, v180, v176, s38
    v_perm_b32 v135, v188, v184, s38
    v_perm_b32 v136, v165, v161, s37
    v_perm_b32 v137, v173, v169, s37
    v_perm_b32 v138, v181, v177, s37
    v_perm_b32 v139, v189, v185, s37
    v_perm_b32 v140, v165, v161, s38
    v_perm_b32 v141, v173, v169, s38
    v_perm_b32 v142, v181, v177, s38
    v_perm_b32 v143, v189, v185, s38
    v_perm_b32 v144, v166, v162, s37
    v_perm_b32 v145, v174, v170, s37
    v_perm_b32 v146, v182, v178, s37
    v_perm_b32 v147, v190, v186, s37
    v_perm_b32 v148, v166, v162, s38
    v_perm_b32 v149, v174, v170, s38
    v_perm_b32 v150, v182, v178, s38
    v_perm_b32 v151, v190, v186, s38
    v_perm_b32 v152, v167, v163, s37
    v_perm_b32 v153, v175, v171, s37
    v_perm_b32 v154, v183, v179, s37
    v_perm_b32 v155, v191, v187, s37
    v_perm_b32 v156, v167, v163, s38
    v_perm_b32 v157, v175, v171, s38
    v_perm_b32 v158, v183, v179, s38
    v_perm_b32 v159, v191, v187, s38
    s_waitcnt vmcnt(8)
    v_perm_b32 v160, v196, v192, s37
    v_perm_b32 v161, v204, v200, s37
    v_perm_b32 v162, v212, v208, s37
    v_perm_b32 v163, v220, v216, s37
    v_perm_b32 v164, v196, v192, s38
    v_perm_b32 v165, v204, v200, s38
    v_perm_b32 v166, v212, v208, s38
    v_perm_b32 v167, v220, v216, s38
    v_perm_b32 v168, v197, v193, s37
    v_perm_b32 v169, v205, v201, s37
    v_perm_b32 v170, v213, v209, s37
    v_perm_b32 v171, v221, v217, s37
    v_perm_b32 v172, v197, v193, s38
    v_perm_b32 v173, v205, v201, s38
    v_perm_b32 v174, v213, v209, s38
    v_perm_b32 v175, v221, v217, s38
    v_perm_b32 v176, v198, v194, s37
    v_perm_b32 v177, v206, v202, s37
    v_perm_b32 v178, v214, v210, s37
    v_perm_b32 v179, v222, v218, s37
    v_perm_b32 v180, v198, v194, s38
    v_perm_b32 v181, v206, v202, s38
    v_perm_b32 v182, v214, v210, s38
    v_perm_b32 v183, v222, v218, s38
    v_perm_b32 v184, v199, v195, s37
    v_perm_b32 v185, v207, v203, s37
    v_perm_b32 v186, v215, v211, s37
    v_perm_b32 v187, v223, v219, s37
    v_perm_b32 v188, v199, v195, s38
    v_perm_b32 v189, v207, v203, s38
    v_perm_b32 v190, v215, v211, s38
    v_perm_b32 v191, v223, v219, s38
    s_waitcnt vmcnt(0)
    v_perm_b32 v192, v228, v224, s37
    v_perm_b32 v193, v236, v232, s37
    v_perm_b32 v194, v244, v240, s37
    v_perm_b32 v195, v252, v248, s37
    v_perm_b32 v196, v228, v224, s38
    v_perm_b32 v197, v236, v232, s38
    v_perm_b32 v198, v244, v240, s38
    v_perm_b32 v199, v252, v248, s38
    v_perm_b32 v200, v229, v225, s37
    v_perm_b32 v201, v237, v233, s37
    v_perm_b32 v202, v245, v241, s37
    v_perm_b32 v203, v253, v249, s37
    v_perm_b32 v204, v229, v225, s38
    v_perm_b32 v205, v237, v233, s38
    v_perm_b32 v206, v245, v241, s38
    v_perm_b32 v207, v253, v249, s38
    v_perm_b32 v208, v230, v226, s37
    v_perm_b32 v209, v238, v234, s37
    v_perm_b32 v210, v246, v242, s37
    v_perm_b32 v211, v254, v250, s37
    v_perm_b32 v212, v230, v226, s38
    v_perm_b32 v213, v238, v234, s38
    v_perm_b32 v214, v246, v242, s38
    v_perm_b32 v215, v254, v250, s38
    v_perm_b32 v216, v231, v227, s37
    v_perm_b32 v217, v239, v235, s37
    v_perm_b32 v218, v247, v243, s37
    v_perm_b32 v219, v255, v251, s37
    v_perm_b32 v220, v231, v227, s38
    v_perm_b32 v221, v239, v235, s38
    v_perm_b32 v222, v247, v243, s38
    v_perm_b32 v223, v255, v251, s38
    s_mov_b32 s45, 3200000
L_lw_25:
    ds_read_b32 v8, v7 offset:28
    s_waitcnt lgkmcnt(0)
    v_readfirstlane_b32 s52, v8
    s_cmp_lg_u32 s52, 0
    s_cbranch_scc1 L_lwd_26
    s_sleep 1
    s_sub_u32 s45, s45, 1
    s_cmp_lg_u32 s45, 0
    s_cbranch_scc1 L_lw_25
L_lwd_26:
    s_mov_b32 s45, 400000
    s_mov_b64 exec, 0xffff
L_lp_27:
    global_load_dwordx2 v[224:225], v20, s[42:43] offset:1024 sc1
    s_waitcnt vmcnt(0)
    v_cmp_ne_u32 vcc, s46, v225
    s_cbranch_vccz L_lp_27_d
    s_sleep 8
    s_sub_u32 s45, s45, 1
    s_cmp_lg_u32 s45, 0
    s_cbranch_scc1 L_lp_27
L_lp_27_d:
    s_mov_b64 exec, -1
    s_mov_b32 s45, 400000
L_opoll:
    global_load_dwordx4 v[224:227], v20, s[42:43] offset:1024 sc1
    global_load_dwordx4 v[32:35], v14, s[42:43] offset:0 sc1
    global_load_dwordx4 v[36:39], v14, s[42:43] offset:1280 sc1
    global_load_dwordx4 v[40:43], v14, s[42:43] offset:2560 sc1
    global_load_dwordx4 v[44:47], v15, s[42:43] offset:0 sc1
    global_load_dwordx4 v[48:51], v15, s[42:43] offset:1280 sc1
    global_load_dwordx4 v[52:55], v15, s[42:43] offset:2560 sc1
    global_load_dwordx4 v[56:59], v16, s[42:43] offset:0 sc1
    global_load_dwordx4 v[60:63], v16, s[42:43] offset:1280 sc1
    global_load_dwordx4 v[64:67], v16, s[42:43] offset:2560 sc1
    global_load_dwordx4 v[68:71], v17, s[42:43] offset:0 sc1
    global_load_dwordx4 v[72:75], v17, s[42:43] offset:1280 sc1
    global_load_dwordx4 v[76:79], v17, s[42:43] offset:2560 sc1
    global_load_dwordx4 v[80:83], v18, s[42:43] offset:0 sc1
    global_load_dwordx4 v[84:87], v18, s[42:43] offset:1280 sc1
    global_load_dwordx4 v[88:91], v18, s[42:43] offset:2560 sc1
    global_load_dwordx4 v[92:95], v19, s[42:43] offset:0 sc1
    s_waitcnt vmcnt(0)
    v_max3_u32 v8, v33, v35, v227
    v_min3_u32 v9, v33, v35, v227
    v_max3_u32 v8, v8, v37, v39
    v_min3_u32 v9, v9, v37, v39
    v_max3_u32 v8, v8, v41, v43
    v_min3_u32 v9, v9, v41, v43
    v_max3_u32 v8, v8, v45, v47
    v_min3_u32 v9, v9, v45, v47
    v_max3_u32 v8, v8, v49, v51
    v_min3_u32 v9, v9, v49, v51
    v_max3_u32 v8, v8, v53, v55
    v_min3_u32 v9, v9, v53, v55
    v_max3_u32 v8, v8, v57, v59
    v_min3_u32 v9, v9, v57, v59
    v_max3_u32 v8, v8, v61, v63
    v_min3_u32 v9, v9, v61, v63
    v_max3_u32 v8, v8, v65, v67
    v_min3_u32 v9, v9, v65, v67
    v_max3_u32 v8, v8, v69, v71
    v_min3_u32 v9, v9, v69, v71
    v_max3_u32 v8, v8, v73, v75
    v_min3_u32 v9, v9, v73, v75
    v_max3_u32 v8, v8, v77, v79
    v_min3_u32 v9, v9, v77, v79
    v_max3_u32 v8, v8, v81, v83
    v_min3_u32 v9, v9, v81, v83
    v_max3_u32 v8, v8, v85, v87
    v_min3_u32 v9, v9, v85, v87
    v_max3_u32 v8, v8, v89, v91
    v_min3_u32 v9, v9, v89, v91
    v_max3_u32 v8, v8, v93, v95
    v_min3_u32 v9, v9, v93, v95
    v_max3_u32 v8, v8, v225, v227
    v_min3_u32 v9, v9, v225, v227
    v_xor_b32 v8, s46, v8
    v_xor_b32 v9, s46, v9
    v_or_b32 v8, v8, v9
    v_cmp_ne_u32 vcc, 0, v8
    s_cbranch_vccz L_opoll_done
    s_sleep 16
    s_sub_u32 s45, s45, 1
    s_cmp_lg_u32 s45, 0
    s_cbranch_scc1 L_opoll
L_opoll_done:
    v_mov_b32 v10, v224
    s_nop 1
    v_max_f32_dpp v10, v10, v10 quad_perm:[1,0,3,2] row_mask:0xf bank_mask:0xf
    s_nop 1
    v_max_f32_dpp v10, v10, v10 quad_perm:[2,3,0,1] row_mask:0xf bank_mask:0xf
    s_nop 1
    v_max_f32_dpp v10, v10, v10 row_half_mirror row_mask:0xf bank_mask:0xf
    s_nop 1
    v_max_f32_dpp v10, v10, v10 row_mirror row_mask:0xf bank_mask:0xf
    v_sub_f32 v224, v224, v10
    v_mul_f32 v224, s44, v224
    v_exp_f32 v224, v224
    s_nop 0
    v_mul_f32 v11, v224, v226
    s_nop 1
    v_add_f32_dpp v11, v11, v11 quad_perm:[1,0,3,2] row_mask:0xf bank_mask:0xf
    s_nop 1
    v_add_f32_dpp v11, v11, v11 quad_perm:[2,3,0,1] row_mask:0xf bank_mask:0xf
    s_nop 1
    v_add_f32_dpp v11, v11, v11 row_half_mirror row_mask:0xf bank_mask:0xf
    s_nop 1
    v_add_f32_dpp v11, v11, v11 row_mirror row_mask:0xf bank_mask:0xf
    v_rcp_f32 v11, v11
    s_nop 0
    v_mul_f32 v224, v224, v11
    s_nop 0
    v_readlane_b32 s80, v224, 0
    v_readlane_b32 s81, v224, 1
    v_readlane_b32 s82, v224, 2
    v_readlane_b32 s83, v224, 3
    v_readlane_b32 s84, v224, 4
    v_readlane_b32 s85, v224, 5
    v_readlane_b32 s86, v224, 6
    v_readlane_b32 s87, v224, 7
    v_readlane_b32 s88, v224, 8
    v_readlane_b32 s89, v224, 9
    v_readlane_b32 s90, v224, 10
    v_readlane_b32 s91, v224, 11
    v_readlane_b32 s92, v224, 12
    v_readlane_b32 s93, v224, 13
    v_readlane_b32 s94, v224, 14
    v_readlane_b32 s95, v224, 15
    s_nop 1
    v_mul_f32 v228, s80, v32
    v_mul_f32 v229, s80, v34
    v_fmac_f32 v228, s81, v36
    v_fmac_f32 v229, s81, v38
    v_fmac_f32 v228, s82, v40
    v_fmac_f32 v229, s82, v42
    v_fmac_f32 v228, s83, v44
    v_fmac_f32 v229, s83, v46
    v_fmac_f32 v228, s84, v48
    v_fmac_f32 v229, s84, v50
    v_fmac_f32 v228, s85, v52
    v_fmac_f32 v229, s85, v54
    v_fmac_f32 v228, s86, v56
    v_fmac_f32 v229, s86, v58
    v_fmac_f32 v228, s87, v60
    v_fmac_f32 v229, s87, v62
    v_fmac_f32 v228, s88, v64
    v_fmac_f32 v229, s88, v66
    v_fmac_f32 v228, s89, v68
    v_fmac_f32 v229, s89, v70
    v_fmac_f32 v228, s90, v72
    v_fmac_f32 v229, s90, v74
    v_fmac_f32 v228, s91, v76
    v_fmac_f32 v229, s91, v78
    v_fmac_f32 v228, s92, v80
    v_fmac_f32 v229, s92, v82
    v_fmac_f32 v228, s93, v84
    v_fmac_f32 v229, s93, v86
    v_fmac_f32 v228, s94, v88
    v_fmac_f32 v229, s94, v90
    v_fmac_f32 v228, s95, v92
    v_fmac_f32 v229, s95, v94
    v_cvt_pk_bf16_f32 v228, v228, v229
    v_lshlrev_b32 v8, 2, v1
    ds_write_b32 v8, v228 offset:768
    v_lshlrev_b32 v8, 4, v4
    s_waitcnt lgkmcnt(0)
    ds_read_b128 v[64:67], v8 offset:768
    ds_read_b128 v[68:71], v8 offset:832
    ds_read_b128 v[72:75], v8 offset:896
    ds_read_b128 v[76:79], v8 offset:960
    s_waitcnt lgkmcnt(0)
    v_mfma_f32_16x16x32_bf16 v[32:35], v[64:67], v[96:99], 0
    v_mfma_f32_16x16x32_bf16 v[36:39], v[64:67], v[100:103], 0
    v_mfma_f32_16x16x32_bf16 v[40:43], v[64:67], v[104:107], 0
    v_mfma_f32_16x16x32_bf16 v[44:47], v[64:67], v[108:111], 0
    v_mfma_f32_16x16x32_bf16 v[48:51], v[64:67], v[112:115], 0
    v_mfma_f32_16x16x32_bf16 v[52:55], v[64:67], v[116:119], 0
    v_mfma_f32_16x16x32_bf16 v[56:59], v[64:67], v[120:123], 0
    v_mfma_f32_16x16x32_bf16 v[60:63], v[64:67], v[124:127], 0
    v_mfma_f32_16x16x32_bf16 v[32:35], v[68:71], v[128:131], v[32:35]
    v_mfma_f32_16x16x32_bf16 v[36:39], v[68:71], v[132:135], v[36:39]
    v_mfma_f32_16x16x32_bf16 v[40:43], v[68:71], v[136:139], v[40:43]
    v_mfma_f32_16x16x32_bf16 v[44:47], v[68:71], v[140:143], v[44:47]
    v_mfma_f32_16x16x32_bf16 v[48:51], v[68:71], v[144:147], v[48:51]
    v_mfma_f32_16x16x32_bf16 v[52:55], v[68:71], v[148:151], v[52:55]
    v_mfma_f32_16x16x32_bf16 v[56:59], v[68:71], v[152:155], v[56:59]
    v_mfma_f32_16x16x32_bf16 v[60:63], v[68:71], v[156:159], v[60:63]
    v_mfma_f32_16x16x32_bf16 v[32:35], v[72:75], v[160:163], v[32:35]
    v_mfma_f32_16x16x32_bf16 v[36:39], v[72:75], v[164:167], v[36:39]
    v_mfma_f32_16x16x32_bf16 v[40:43], v[72:75], v[168:171], v[40:43]
    v_mfma_f32_16x16x32_bf16 v[44:47], v[72:75], v[172:175], v[44:47]
    v_mfma_f32_16x16x32_bf16 v[48:51], v[72:75], v[176:179], v[48:51]
    v_mfma_f32_16x16x32_bf16 v[52:55], v[72:75], v[180:183], v[52:55]
    v_mfma_f32_16x16x32_bf16 v[56:59], v[72:75], v[184:187], v[56:59]
    v_mfma_f32_16x16x32_bf16 v[60:63], v[72:75], v[188:191], v[60:63]
    v_mfma_f32_16x16x32_bf16 v[32:35], v[76:79], v[192:195], v[32:35]
    v_mfma_f32_16x16x32_bf16 v[36:39], v[76:79], v[196:199], v[36:39]
    v_mfma_f32_16x16x32_bf16 v[40:43], v[76:79], v[200:203], v[40:43]
    v_mfma_f32_16x16x32_bf16 v[44:47], v[76:79], v[204:207], v[44:47]
    v_mfma_f32_16x16x32_bf16 v[48:51], v[76:79], v[208:211], v[48:51]
    v_mfma_f32_16x16x32_bf16 v[52:55], v[76:79], v[212:215], v[52:55]
    v_mfma_f32_16x16x32_bf16 v[56:59], v[76:79], v[216:219], v[56:59]
    v_mfma_f32_16x16x32_bf16 v[60:63], v[76:79], v[220:223], v[60:63]
    v_lshlrev_b32 v8, 6, v3
    s_nop 8
    v_mov_b32 v232, v32
    v_mov_b32 v233, s46
    v_mov_b32 v234, v36
    v_mov_b32 v235, s46
    v_mov_b32 v236, v40
    v_mov_b32 v237, s46
    v_mov_b32 v238, v44
    v_mov_b32 v239, s46
    v_mov_b32 v240, v48
    v_mov_b32 v241, s46
    v_mov_b32 v242, v52
    v_mov_b32 v243, s46
    v_mov_b32 v244, v56
    v_mov_b32 v245, s46
    v_mov_b32 v246, v60
    v_mov_b32 v247, s46
    s_mov_b64 exec, 0x1ff
    global_store_dwordx4 v8, v[232:235], s[48:49] offset:0 sc1
    global_store_dwordx4 v8, v[236:239], s[48:49] offset:16 sc1
    global_store_dwordx4 v8, v[240:243], s[48:49] offset:32 sc1
    global_store_dwordx4 v8, v[244:247], s[48:49] offset:48 sc1
    s_mov_b64 exec, 1
    v_mov_b32 v10, 1
    s_waitcnt lgkmcnt(0)
    ds_add_u32 v7, v10 offset:32
    s_mov_b64 exec, -1
    s_branch L_end
L_x3:
    global_load_dword v9, v7, s[30:31] offset:0 sc1
    s_waitcnt vmcnt(0)
    v_add_u32 v9, 1, v9
    ds_write_b32 v7, v9 offset:24
    v_readfirstlane_b32 s46, v9
    s_mov_b64 exec, 1
    v_mov_b32 v8, 1
    s_waitcnt lgkmcnt(0)
    ds_add_u32 v7, v8 offset:12
    s_mov_b64 exec, -1
    v_min_u32 v9, 8, v3
    v_mul_u32_u24 v12, 9216, v4
    v_lshl_add_u32 v12, v9, 4, v12
    v_add_u32 v13, 4608, v12
    v_and_b32 v14, 1, v4
    v_mul_u32_u24 v14, 9216, v14
    v_lshl_add_u32 v14, v9, 4, v14
    v_add_u32 v15, 4608, v14
    s_lshl_b32 s55, s32, 1
    s_add_u32 s55, s55, s35
    s_mul_i32 s53, s55, 165888
    s_mul_i32 s54, s36, 144
    s_add_u32 s53, s53, s54
    s_add_u32 s40, s24, s53
    s_addc_u32 s41, s25, 0
    s_lshl_b32 s53, s36, 5
    s_lshl_b32 s54, s32, 1
    s_add_u32 s53, s53, s54
    s_add_u32 s53, s53, s35
    s_mul_i32 s53, s53, 1152
    s_add_u32 s53, s53, 2097152
    s_add_u32 s48, s30, s53
    s_addc_u32 s49, s31, 0
    s_mov_b32 s45, 3200000
L_lw_28:
    ds_read_b32 v8, v7 offset:16
    s_waitcnt lgkmcnt(0)
    v_readfirstlane_b32 s52, v8
    s_cmp_eq_u32 s52, 4
    s_cbranch_scc1 L_lwd_29
    s_sleep 2
    s_sub_u32 s45, s45, 1
    s_cmp_lg_u32 s45, 0
    s_cbranch_scc1 L_lw_28
L_lwd_29:
    global_load_dwordx4 v[96:99], v12, s[40:41] offset:0 nt
    global_load_dwordx4 v[100:103], v12, s[40:41] offset:1152 nt
    global_load_dwordx4 v[104:107], v12, s[40:41] offset:2304 nt
    global_load_dwordx4 v[108:111], v12, s[40:41] offset:3456 nt
    global_load_dwordx4 v[112:115], v13, s[40:41] offset:0 nt
    global_load_dwordx4 v[116:119], v13, s[40:41] offset:1152 nt
    global_load_dwordx4 v[120:123], v13, s[40:41] offset:2304 nt
    global_load_dwordx4 v[124:127], v13, s[40:41] offset:3456 nt
    s_add_u32 s40, s40, 36864
    s_addc_u32 s41, s41, 0
    global_load_dwordx4 v[128:131], v12, s[40:41] offset:0 nt
    global_load_dwordx4 v[132:135], v12, s[40:41] offset:1152 nt
    global_load_dwordx4 v[136:139], v12, s[40:41] offset:2304 nt
    global_load_dwordx4 v[140:143], v12, s[40:41] offset:3456 nt
    global_load_dwordx4 v[144:147], v13, s[40:41] offset:0 nt
    global_load_dwordx4 v[148:151], v13, s[40:41] offset:1152 nt
    global_load_dwordx4 v[152:155], v13, s[40:41] offset:2304 nt
    global_load_dwordx4 v[156:159], v13, s[40:41] offset:3456 nt
    s_add_u32 s40, s40, 36864
    s_addc_u32 s41, s41, 0
    global_load_dwordx4 v[160:163], v12, s[40:41] offset:0 nt
    global_load_dwordx4 v[164:167], v12, s[40:41] offset:1152 nt
    global_load_dwordx4 v[168:171], v12, s[40:41] offset:2304 nt
    global_load_dwordx4 v[172:175], v12, s[40:41] offset:3456 nt
    global_load_dwordx4 v[176:179], v13, s[40:41] offset:0 nt
    global_load_dwordx4 v[180:183], v13, s[40:41] offset:1152 nt
    global_load_dwordx4 v[184:187], v13, s[40:41] offset:2304 nt
    global_load_dwordx4 v[188:191], v13, s[40:41] offset:3456 nt
    s_add_u32 s40, s40, 36864
    s_addc_u32 s41, s41, 0
    global_load_dwordx4 v[192:195], v12, s[40:41] offset:0 nt
    global_load_dwordx4 v[196:199], v12, s[40:41] offset:1152 nt
    global_load_dwordx4 v[200:203], v12, s[40:41] offset:2304 nt
    global_load_dwordx4 v[204:207], v12, s[40:41] offset:3456 nt
    global_load_dwordx4 v[208:211], v13, s[40:41] offset:0 nt
    global_load_dwordx4 v[212:215], v13, s[40:41] offset:1152 nt
    global_load_dwordx4 v[216:219], v13, s[40:41] offset:2304 nt
    global_load_dwordx4 v[220:223], v13, s[40:41] offset:3456 nt
    s_add_u32 s40, s40, 36864
    s_addc_u32 s41, s41, 0
    global_load_dwordx4 v[224:227], v14, s[40:41] offset:0 nt
    global_load_dwordx4 v[228:231], v14, s[40:41] offset:1152 nt
    global_load_dwordx4 v[232:235], v14, s[40:41] offset:2304 nt
    global_load_dwordx4 v[236:239], v14, s[40:41] offset:3456 nt
    global_load_dwordx4 v[240:243], v15, s[40:41] offset:0 nt
    global_load_dwordx4 v[244:247], v15, s[40:41] offset:1152 nt
    global_load_dwordx4 v[248:251], v15, s[40:41] offset:2304 nt
    global_load_dwordx4 v[252:255], v15, s[40:41] offset:3456 nt
    s_mov_b32 s45, 3200000
L_lw_30:
    ds_read_b32 v8, v7 offset:4
    s_waitcnt lgkmcnt(0)
    v_readfirstlane_b32 s52, v8
    s_cmp_lg_u32 s52, 0
    s_cbranch_scc1 L_lwd_31
    s_sleep 1
    s_sub_u32 s45, s45, 1
    s_cmp_lg_u32 s45, 0
    s_cbranch_scc1 L_lw_30
L_lwd_31:
    v_lshlrev_b32 v8, 4, v4
    v_lshlrev_b32 v13, 6, v3
    ds_read_b128 v[16:19], v8 offset:1152
    ds_read_b128 v[20:23], v8 offset:1216
    ds_read_b128 v[24:27], v8 offset:1280
    ds_read_b128 v[28:31], v8 offset:1344
    ds_read_b128 v[0:3], v8 offset:1408
    s_waitcnt lgkmcnt(0)
    s_waitcnt vmcnt(32)
    v_perm_b32 v64, v100, v96, s37
    v_perm_b32 v65, v108, v104, s37
    v_perm_b32 v66, v116, v112, s37
    v_perm_b32 v67, v124, v120, s37
    v_perm_b32 v68, v100, v96, s38
    v_perm_b32 v69, v108, v104, s38
    v_perm_b32 v70, v116, v112, s38
    v_perm_b32 v71, v124, v120, s38
    v_perm_b32 v72, v101, v97, s37
    v_perm_b32 v73, v109, v105, s37
    v_perm_b32 v74, v117, v113, s37
    v_perm_b32 v75, v125, v121, s37
    v_perm_b32 v76, v101, v97, s38
    v_perm_b32 v77, v109, v105, s38
    v_perm_b32 v78, v117, v113, s38
    v_perm_b32 v79, v125, v121, s38
    v_perm_b32 v80, v102, v98, s37
    v_perm_b32 v81, v110, v106, s37
    v_perm_b32 v82, v118, v114, s37
    v_perm_b32 v83, v126, v122, s37
    v_perm_b32 v84, v102, v98, s38
    v_perm_b32 v85, v110, v106, s38
    v_perm_b32 v86, v118, v114, s38
    v_perm_b32 v87, v126, v122, s38
    v_perm_b32 v88, v103, v99, s37
    v_perm_b32 v89, v111, v107, s37
    v_perm_b32 v90, v119, v115, s37
    v_perm_b32 v91, v127, v123, s37
    v_perm_b32 v92, v103, v99, s38
    v_perm_b32 v93, v111, v107, s38
    v_perm_b32 v94, v119, v115, s38
    v_perm_b32 v95, v127, v123, s38
    s_nop 1
    v_mfma_f32_16x16x32_bf16 v[32:35], v[16:19], v[64:67], 0
    v_mfma_f32_16x16x32_bf16 v[36:39], v[16:19], v[68:71], 0
    v_mfma_f32_16x16x32_bf16 v[40:43], v[16:19], v[72:75], 0
    v_mfma_f32_16x16x32_bf16 v[44:47], v[16:19], v[76:79], 0
    v_mfma_f32_16x16x32_bf16 v[48:51], v[16:19], v[80:83], 0
    v_mfma_f32_16x16x32_bf16 v[52:55], v[16:19], v[84:87], 0
    v_mfma_f32_16x16x32_bf16 v[56:59], v[16:19], v[88:91], 0
    v_mfma_f32_16x16x32_bf16 v[60:63], v[16:19], v[92:95], 0
    s_waitcnt vmcnt(24)
    v_perm_b32 v64, v132, v128, s37
    v_perm_b32 v65, v140, v136, s37
    v_perm_b32 v66, v148, v144, s37
    v_perm_b32 v67, v156, v152, s37
    v_perm_b32 v68, v132, v128, s38
    v_perm_b32 v69, v140, v136, s38
    v_perm_b32 v70, v148, v144, s38
    v_perm_b32 v71, v156, v152, s38
    v_perm_b32 v72, v133, v129, s37
    v_perm_b32 v73, v141, v137, s37
    v_perm_b32 v74, v149, v145, s37
    v_perm_b32 v75, v157, v153, s37
    v_perm_b32 v76, v133, v129, s38
    v_perm_b32 v77, v141, v137, s38
    v_perm_b32 v78, v149, v145, s38
    v_perm_b32 v79, v157, v153, s38
    v_perm_b32 v80, v134, v130, s37
    v_perm_b32 v81, v142, v138, s37
    v_perm_b32 v82, v150, v146, s37
    v_perm_b32 v83, v158, v154, s37
    v_perm_b32 v84, v134, v130, s38
    v_perm_b32 v85, v142, v138, s38
    v_perm_b32 v86, v150, v146, s38
    v_perm_b32 v87, v158, v154, s38
    v_perm_b32 v88, v135, v131, s37
    v_perm_b32 v89, v143, v139, s37
    v_perm_b32 v90, v151, v147, s37
    v_perm_b32 v91, v159, v155, s37
    v_perm_b32 v92, v135, v131, s38
    v_perm_b32 v93, v143, v139, s38
    v_perm_b32 v94, v151, v147, s38
    v_perm_b32 v95, v159, v155, s38
    s_nop 1
    v_mfma_f32_16x16x32_bf16 v[32:35], v[20:23], v[64:67], v[32:35]
    v_mfma_f32_16x16x32_bf16 v[36:39], v[20:23], v[68:71], v[36:39]
    v_mfma_f32_16x16x32_bf16 v[40:43], v[20:23], v[72:75], v[40:43]
    v_mfma_f32_16x16x32_bf16 v[44:47], v[20:23], v[76:79], v[44:47]
    v_mfma_f32_16x16x32_bf16 v[48:51], v[20:23], v[80:83], v[48:51]
    v_mfma_f32_16x16x32_bf16 v[52:55], v[20:23], v[84:87], v[52:55]
    v_mfma_f32_16x16x32_bf16 v[56:59], v[20:23], v[88:91], v[56:59]
    v_mfma_f32_16x16x32_bf16 v[60:63], v[20:23], v[92:95], v[60:63]
    s_waitcnt vmcnt(16)
    v_perm_b32 v64, v164, v160, s37
    v_perm_b32 v65, v172, v168, s37
    v_perm_b32 v66, v180, v176, s37
    v_perm_b32 v67, v188, v184, s37
    v_perm_b32 v68, v164, v160, s38
    v_perm_b32 v69, v172, v168, s38
    v_perm_b32 v70, v180, v176, s38
    v_perm_b32 v71, v188, v184, s38
    v_perm_b32 v72, v165, v161, s37
    v_perm_b32 v73, v173, v169, s37
    v_perm_b32 v74, v181, v177, s37
    v_perm_b32 v75, v189, v185, s37
    v_perm_b32 v76, v165, v161, s38
    v_perm_b32 v77, v173, v169, s38
    v_perm_b32 v78, v181, v177, s38
    v_perm_b32 v79, v189, v185, s38
    v_perm_b32 v80, v166, v162, s37
    v_perm_b32 v81, v174, v170, s37
    v_perm_b32 v82, v182, v178, s37
    v_perm_b32 v83, v190, v186, s37
    v_perm_b32 v84, v166, v162, s38
    v_perm_b32 v85, v174, v170, s38
    v_perm_b32 v86, v182, v178, s38
    v_perm_b32 v87, v190, v186, s38
    v_perm_b32 v88, v167, v163, s37
    v_perm_b32 v89, v175, v171, s37
    v_perm_b32 v90, v183, v179, s37
    v_perm_b32 v91, v191, v187, s37
    v_perm_b32 v92, v167, v163, s38
    v_perm_b32 v93, v175, v171, s38
    v_perm_b32 v94, v183, v179, s38
    v_perm_b32 v95, v191, v187, s38
    s_nop 1
    v_mfma_f32_16x16x32_bf16 v[32:35], v[24:27], v[64:67], v[32:35]
    v_mfma_f32_16x16x32_bf16 v[36:39], v[24:27], v[68:71], v[36:39]
    v_mfma_f32_16x16x32_bf16 v[40:43], v[24:27], v[72:75], v[40:43]
    v_mfma_f32_16x16x32_bf16 v[44:47], v[24:27], v[76:79], v[44:47]
    v_mfma_f32_16x16x32_bf16 v[48:51], v[24:27], v[80:83], v[48:51]
    v_mfma_f32_16x16x32_bf16 v[52:55], v[24:27], v[84:87], v[52:55]
    v_mfma_f32_16x16x32_bf16 v[56:59], v[24:27], v[88:91], v[56:59]
    v_mfma_f32_16x16x32_bf16 v[60:63], v[24:27], v[92:95], v[60:63]
    s_waitcnt vmcnt(8)
    v_perm_b32 v64, v196, v192, s37
    v_perm_b32 v65, v204, v200, s37
    v_perm_b32 v66, v212, v208, s37
    v_perm_b32 v67, v220, v216, s37
    v_perm_b32 v68, v196, v192, s38
    v_perm_b32 v69, v204, v200, s38
    v_perm_b32 v70, v212, v208, s38
    v_perm_b32 v71, v220, v216, s38
    v_perm_b32 v72, v197, v193, s37
    v_perm_b32 v73, v205, v201, s37
    v_perm_b32 v74, v213, v209, s37
    v_perm_b32 v75, v221, v217, s37
    v_perm_b32 v76, v197, v193, s38
    v_perm_b32 v77, v205, v201, s38
    v_perm_b32 v78, v213, v209, s38
    v_perm_b32 v79, v221, v217, s38
    v_perm_b32 v80, v198, v194, s37
    v_perm_b32 v81, v206, v202, s37
    v_perm_b32 v82, v214, v210, s37
    v_perm_b32 v83, v222, v218, s37
    v_perm_b32 v84, v198, v194, s38
    v_perm_b32 v85, v206, v202, s38
    v_perm_b32 v86, v214, v210, s38
    v_perm_b32 v87, v222, v218, s38
    v_perm_b32 v88, v199, v195, s37
    v_perm_b32 v89, v207, v203, s37
    v_perm_b32 v90, v215, v211, s37
    v_perm_b32 v91, v223, v219, s37
    v_perm_b32 v92, v199, v195, s38
    v_perm_b32 v93, v207, v203, s38
    v_perm_b32 v94, v215, v211, s38
    v_perm_b32 v95, v223, v219, s38
    s_nop 1
    v_mfma_f32_16x16x32_bf16 v[32:35], v[28:31], v[64:67], v[32:35]
    v_mfma_f32_16x16x32_bf16 v[36:39], v[28:31], v[68:71], v[36:39]
    v_mfma_f32_16x16x32_bf16 v[40:43], v[28:31], v[72:75], v[40:43]
    v_mfma_f32_16x16x32_bf16 v[44:47], v[28:31], v[76:79], v[44:47]
    v_mfma_f32_16x16x32_bf16 v[48:51], v[28:31], v[80:83], v[48:51]
    v_mfma_f32_16x16x32_bf16 v[52:55], v[28:31], v[84:87], v[52:55]
    v_mfma_f32_16x16x32_bf16 v[56:59], v[28:31], v[88:91], v[56:59]
    v_mfma_f32_16x16x32_bf16 v[60:63], v[28:31], v[92:95], v[60:63]
    s_waitcnt vmcnt(0)
    v_perm_b32 v64, v228, v224, s37
    v_perm_b32 v65, v236, v232, s37
    v_perm_b32 v66, v244, v240, s37
    v_perm_b32 v67, v252, v248, s37
    v_perm_b32 v68, v228, v224, s38
    v_perm_b32 v69, v236, v232, s38
    v_perm_b32 v70, v244, v240, s38
    v_perm_b32 v71, v252, v248, s38
    v_perm_b32 v72, v229, v225, s37
    v_perm_b32 v73, v237, v233, s37
    v_perm_b32 v74, v245, v241, s37
    v_perm_b32 v75, v253, v249, s37
    v_perm_b32 v76, v229, v225, s38
    v_perm_b32 v77, v237, v233, s38
    v_perm_b32 v78, v245, v241, s38
    v_perm_b32 v79, v253, v249, s38
    v_perm_b32 v80, v230, v226, s37
    v_perm_b32 v81, v238, v234, s37
    v_perm_b32 v82, v246, v242, s37
    v_perm_b32 v83, v254, v250, s37
    v_perm_b32 v84, v230, v226, s38
    v_perm_b32 v85, v238, v234, s38
    v_perm_b32 v86, v246, v242, s38
    v_perm_b32 v87, v254, v250, s38
    v_perm_b32 v88, v231, v227, s37
    v_perm_b32 v89, v239, v235, s37
    v_perm_b32 v90, v247, v243, s37
    v_perm_b32 v91, v255, v251, s37
    v_perm_b32 v92, v231, v227, s38
    v_perm_b32 v93, v239, v235, s38
    v_perm_b32 v94, v247, v243, s38
    v_perm_b32 v95, v255, v251, s38
    s_nop 1
    v_mfma_f32_16x16x32_bf16 v[32:35], v[0:3], v[64:67], v[32:35]
    v_mfma_f32_16x16x32_bf16 v[36:39], v[0:3], v[68:71], v[36:39]
    v_mfma_f32_16x16x32_bf16 v[40:43], v[0:3], v[72:75], v[40:43]
    v_mfma_f32_16x16x32_bf16 v[44:47], v[0:3], v[76:79], v[44:47]
    v_mfma_f32_16x16x32_bf16 v[48:51], v[0:3], v[80:83], v[48:51]
    v_mfma_f32_16x16x32_bf16 v[52:55], v[0:3], v[84:87], v[52:55]
    v_mfma_f32_16x16x32_bf16 v[56:59], v[0:3], v[88:91], v[56:59]
    v_mfma_f32_16x16x32_bf16 v[60:63], v[0:3], v[92:95], v[60:63]
    s_nop 9
    v_mov_b32 v64, v32
    v_mov_b32 v65, s46
    v_mov_b32 v66, v36
    v_mov_b32 v67, s46
    v_mov_b32 v68, v40
    v_mov_b32 v69, s46
    v_mov_b32 v70, v44
    v_mov_b32 v71, s46
    v_mov_b32 v72, v48
    v_mov_b32 v73, s46
    v_mov_b32 v74, v52
    v_mov_b32 v75, s46
    v_mov_b32 v76, v56
    v_mov_b32 v77, s46
    v_mov_b32 v78, v60
    v_mov_b32 v79, s46
    s_mov_b64 exec, 0x1ff
    global_store_dwordx4 v13, v[64:67], s[48:49] offset:576 sc1
    global_store_dwordx4 v13, v[68:71], s[48:49] offset:592 sc1
    global_store_dwordx4 v13, v[72:75], s[48:49] offset:608 sc1
    global_store_dwordx4 v13, v[76:79], s[48:49] offset:624 sc1
    s_mov_b64 exec, 1
    v_mov_b32 v10, 1
    s_waitcnt lgkmcnt(0)
    ds_add_u32 v7, v10 offset:36
    s_mov_b64 exec, -1
L_end:
    s_endpgm
.section .rodata,"a"
.p2align 6
.amdhsa_kernel parallel_sum__gqa_block_cached__swiglu_ffn__decode_kernel
  .amdhsa_next_free_vgpr 256
  .amdhsa_next_free_sgpr 96
  .amdhsa_accum_offset 256
  .amdhsa_group_segment_fixed_size 0
  .amdhsa_kernarg_size 96
  .amdhsa_user_sgpr_count 2
  .amdhsa_user_sgpr_kernarg_segment_ptr 1
  .amdhsa_system_sgpr_workgroup_id_x 1
.end_amdhsa_kernel
```
